```python
import torch

def _softmax(x, axis=-1):
    return torch.softmax(x, dim=axis)
def _gelu(x):
    return torch.nn.functional.gelu(x, approximate="tanh")
def _silu(x):
    return torch.nn.functional.silu(x)
def _sigmoid(x):
    return torch.sigmoid(x)
def _layernorm(x, axis=-1, eps=1e-5):
    m = x.mean(dim=axis, keepdim=True)
    v = x.var(dim=axis, keepdim=True, unbiased=False)
    return (x - m) / torch.sqrt(v + eps)
def _scatter_add(tgt, idx, src, axis=0):
    return tgt.clone().index_add_(axis, idx, src)
def _segment_sum(src, seg, n):
    out = torch.zeros((n,) + src.shape[1:], dtype=src.dtype)
    return out.index_add_(0, seg, src)
def _pad(x, pw):
    flat = tuple(v for pair in reversed(pw) for v in pair)
    return torch.nn.functional.pad(x, flat)

kernel_name = 'interleave_layers__spectral_fnet__glu_gated_glu__prompt'

def setup_inputs():

    _w = (lambda a: (lambda t: t.to(torch.bfloat16) if t.is_floating_point() else t)(torch.as_tensor(a)))
    def _A_setup():
        B, S, D = 1, 2048, 1024
        ns = torch.arange(S)[:, None] * torch.arange(S)[None, :]
        nd = torch.arange(D)[:, None] * torch.arange(D)[None, :]
        Ws_re = torch.cos(-2.0 * torch.pi * ns / S).to(float)
        Ws_im = torch.sin(-2.0 * torch.pi * ns / S).to(float)
        Wd_re = torch.cos(-2.0 * torch.pi * nd / D).to(float)
        Wd_im = torch.sin(-2.0 * torch.pi * nd / D).to(float)
        return {
            "x": _w((lambda *s: torch.randn(*s, dtype=torch.bfloat16) * 0.05)(B, S, D)),
            "dft_seq_re": _w(Ws_re),
            "dft_seq_im": _w(Ws_im),
            "dft_hid_re": _w(Wd_re),
            "dft_hid_im": _w(Wd_im),
        }
    _A_in = _A_setup()

    def _B_setup():
        B, S, D, F = 1, 2048, 1024, 3584
        return {
            "x": _w((lambda *s: torch.randn(*s, dtype=torch.bfloat16) * 0.05)(B, S, D)),
            "w_gate": _w((lambda *s: torch.randn(*s, dtype=torch.bfloat16) * 1.6)(D, F)),
            "w_up": _w((lambda *s: torch.randn(*s, dtype=torch.bfloat16) * 0.8)(D, F)),
            "w_down": _w((lambda *s: torch.randn(*s, dtype=torch.bfloat16) * 0.8)(F, D)),
        }
    _B_in = _B_setup()

    return {
        "A_x": _A_in["x"],
        "A_dft_seq_re": _A_in["dft_seq_re"],
        "A_dft_seq_im": _A_in["dft_seq_im"],
        "A_dft_hid_re": _A_in["dft_hid_re"],
        "A_dft_hid_im": _A_in["dft_hid_im"],
        "B_x": _B_in["x"],
        "B_w_gate": _B_in["w_gate"],
        "B_w_up": _B_in["w_up"],
        "B_w_down": _B_in["w_down"],
    }

def reference(A_x, A_dft_seq_re, A_dft_seq_im, A_dft_hid_re, A_dft_hid_im, B_x, B_w_gate, B_w_up, B_w_down):
    def _A_ref(x, dft_seq_re, dft_seq_im, dft_hid_re, dft_hid_im):
        a = torch.einsum("bsd,ed->bse", x, dft_hid_re)
        b = torch.einsum("bsd,ed->bse", x, dft_hid_im)
        y = torch.einsum("ts,bse->bte", dft_seq_re, a) - torch.einsum("ts,bse->bte", dft_seq_im, b)
        return y

    def _B_ref(x, w_gate, w_up, w_down):
        g = torch.einsum("bsd,df->bsf", x, w_gate)
        u = torch.einsum("bsd,df->bsf", x, w_up)
        h = _sigmoid(g) * u
        return torch.einsum("bsf,fd->bsd", h, w_down)

    x = A_x
    x = x + _A_ref(_layernorm(x, axis=-1), A_dft_seq_re, A_dft_seq_im, A_dft_hid_re, A_dft_hid_im)
    x = x + _B_ref(_layernorm(x, axis=-1), B_w_gate, B_w_up, B_w_down)
    x = x + _A_ref(_layernorm(x, axis=-1), A_dft_seq_re, A_dft_seq_im, A_dft_hid_re, A_dft_hid_im)
    x = x + _B_ref(_layernorm(x, axis=-1), B_w_gate, B_w_up, B_w_down)
    return x
```

```asm
; @launch kernel=il_ln_first_kernel grid=(512,1,1) block=(256,1,1) lds=0
; @launch kernel=il_g1_kernel grid=(256,1,1) block=(256,1,1) lds=131072
; @launch kernel=il_g2_kernel grid=(256,1,1) block=(256,1,1) lds=131072
; @launch kernel=il_ln_pq_kernel grid=(512,1,1) block=(256,1,1) lds=0
; @launch kernel=il_g3_kernel grid=(224,1,1) block=(512,1,1) lds=131072
; @launch kernel=il_g4_kernel grid=(256,1,1) block=(256,1,1) lds=131072
; @launch kernel=il_ln_o_kernel grid=(512,1,1) block=(256,1,1) lds=0
; @launch kernel=il_g1_kernel grid=(256,1,1) block=(256,1,1) lds=131072
; @launch kernel=il_g2_kernel grid=(256,1,1) block=(256,1,1) lds=131072
; @launch kernel=il_ln_pq_kernel grid=(512,1,1) block=(256,1,1) lds=0
; @launch kernel=il_g3_kernel grid=(224,1,1) block=(512,1,1) lds=131072
; @launch kernel=il_g4_kernel grid=(256,1,1) block=(256,1,1) lds=131072
; @launch kernel=il_ln_final_kernel grid=(512,1,1) block=(256,1,1) lds=0
.amdgcn_target "amdgcn-amd-amdhsa--gfx950"
.text
.globl il_ln_first_kernel
.p2align 8
.type il_ln_first_kernel,@function
il_ln_first_kernel:
    s_cmp_ge_u32 s2, 512
    s_cbranch_scc1 il_ln_first_kernel_end_1
    s_load_dwordx2 s[20:21], s[0:1], 88
    s_load_dwordx2 s[22:23], s[0:1], 0
    s_lshl_b32 s3, s2, 13
    v_lshlrev_b32 v1, 4, v0
    v_lshrrev_b32 v2, 6, v0
    v_lshl_add_u32 v1, v2, 10, v1
    s_waitcnt lgkmcnt(0)
    s_mov_b32 s4, s22
    s_mov_b32 s5, s23
    s_mov_b32 s6, 0x400000
    s_and_b32 s5, s5, 0xffff
    s_mov_b32 s7, 0x20000
    buffer_load_dwordx4 v[4:7], v1, s[4:7], s3 offen
    buffer_load_dwordx4 v[8:11], v1, s[4:7], s3 offen offset:1024
    s_mov_b32 s30, 0xffff0000
    s_mov_b32 s32, s20
    s_mov_b32 s33, s21
    s_mov_b32 s34, 0x400000
    s_and_b32 s33, s33, 0xffff
    s_mov_b32 s35, 0x20000
    s_add_u32 s36, s20, 0x400000
    s_addc_u32 s37, s21, 0
    s_mov_b32 s38, 0x400000
    s_and_b32 s37, s37, 0xffff
    s_mov_b32 s39, 0x20000
    s_waitcnt vmcnt(0)
    buffer_store_dwordx4 v[4:7], v1, s[32:35], s3 offen sc1
    buffer_store_dwordx4 v[8:11], v1, s[32:35], s3 offen offset:1024 sc1
    v_lshlrev_b32 v32, 16, v4
    v_and_b32 v33, s30, v4
    v_lshlrev_b32 v34, 16, v5
    v_and_b32 v35, s30, v5
    v_lshlrev_b32 v36, 16, v6
    v_and_b32 v37, s30, v6
    v_lshlrev_b32 v38, 16, v7
    v_and_b32 v39, s30, v7
    v_lshlrev_b32 v40, 16, v8
    v_and_b32 v41, s30, v8
    v_lshlrev_b32 v42, 16, v9
    v_and_b32 v43, s30, v9
    v_lshlrev_b32 v44, 16, v10
    v_and_b32 v45, s30, v10
    v_lshlrev_b32 v46, 16, v11
    v_and_b32 v47, s30, v11
    v_add_f32 v56, v32, v33
    v_add_f32 v56, v56, v34
    v_add_f32 v56, v56, v35
    v_add_f32 v56, v56, v36
    v_add_f32 v56, v56, v37
    v_add_f32 v56, v56, v38
    v_add_f32 v56, v56, v39
    v_add_f32 v56, v56, v40
    v_add_f32 v56, v56, v41
    v_add_f32 v56, v56, v42
    v_add_f32 v56, v56, v43
    v_add_f32 v56, v56, v44
    v_add_f32 v56, v56, v45
    v_add_f32 v56, v56, v46
    v_add_f32 v56, v56, v47
    s_nop 1
    v_add_f32_dpp v56, v56, v56 quad_perm:[1,0,3,2] row_mask:0xf bank_mask:0xf
    s_nop 1
    v_add_f32_dpp v56, v56, v56 quad_perm:[2,3,0,1] row_mask:0xf bank_mask:0xf
    s_nop 1
    v_add_f32_dpp v56, v56, v56 row_half_mirror row_mask:0xf bank_mask:0xf
    s_nop 1
    v_add_f32_dpp v56, v56, v56 row_mirror row_mask:0xf bank_mask:0xf
    s_nop 1
    v_readlane_b32 s40, v56, 0
    v_readlane_b32 s41, v56, 16
    v_readlane_b32 s42, v56, 32
    v_readlane_b32 s43, v56, 48
    s_nop 3
    v_mov_b32 v56, s40
    v_add_f32 v56, s41, v56
    v_add_f32 v56, s42, v56
    v_add_f32 v56, s43, v56
    v_mul_f32 v56, 0x3a800000, v56
    v_sub_f32 v48, v32, v56
    v_mul_f32 v57, v48, v48
    v_sub_f32 v48, v33, v56
    v_fmac_f32 v57, v48, v48
    v_sub_f32 v48, v34, v56
    v_fmac_f32 v57, v48, v48
    v_sub_f32 v48, v35, v56
    v_fmac_f32 v57, v48, v48
    v_sub_f32 v48, v36, v56
    v_fmac_f32 v57, v48, v48
    v_sub_f32 v48, v37, v56
    v_fmac_f32 v57, v48, v48
    v_sub_f32 v48, v38, v56
    v_fmac_f32 v57, v48, v48
    v_sub_f32 v48, v39, v56
    v_fmac_f32 v57, v48, v48
    v_sub_f32 v48, v40, v56
    v_fmac_f32 v57, v48, v48
    v_sub_f32 v48, v41, v56
    v_fmac_f32 v57, v48, v48
    v_sub_f32 v48, v42, v56
    v_fmac_f32 v57, v48, v48
    v_sub_f32 v48, v43, v56
    v_fmac_f32 v57, v48, v48
    v_sub_f32 v48, v44, v56
    v_fmac_f32 v57, v48, v48
    v_sub_f32 v48, v45, v56
    v_fmac_f32 v57, v48, v48
    v_sub_f32 v48, v46, v56
    v_fmac_f32 v57, v48, v48
    v_sub_f32 v48, v47, v56
    v_fmac_f32 v57, v48, v48
    s_nop 1
    v_add_f32_dpp v57, v57, v57 quad_perm:[1,0,3,2] row_mask:0xf bank_mask:0xf
    s_nop 1
    v_add_f32_dpp v57, v57, v57 quad_perm:[2,3,0,1] row_mask:0xf bank_mask:0xf
    s_nop 1
    v_add_f32_dpp v57, v57, v57 row_half_mirror row_mask:0xf bank_mask:0xf
    s_nop 1
    v_add_f32_dpp v57, v57, v57 row_mirror row_mask:0xf bank_mask:0xf
    s_nop 1
    v_readlane_b32 s40, v57, 0
    v_readlane_b32 s41, v57, 16
    v_readlane_b32 s42, v57, 32
    v_readlane_b32 s43, v57, 48
    s_nop 3
    v_mov_b32 v57, s40
    v_add_f32 v57, s41, v57
    v_add_f32 v57, s42, v57
    v_add_f32 v57, s43, v57
    v_mul_f32 v57, 0x3a800000, v57
    v_cvt_pk_bf16_f32 v56, v56, v57
    v_and_b32 v57, s30, v56
    v_lshlrev_b32 v56, 16, v56
    v_add_f32 v57, 0x3727c5ac, v57
    v_cvt_pk_bf16_f32 v57, v57, v57
    v_lshlrev_b32 v57, 16, v57
    v_sqrt_f32 v57, v57
    s_nop 0
    v_cvt_pk_bf16_f32 v57, v57, v57
    v_lshlrev_b32 v57, 16, v57
    v_rcp_f32 v58, v57
    v_sub_f32 v32, v32, v56
    v_sub_f32 v33, v33, v56
    v_cvt_pk_bf16_f32 v48, v32, v33
    v_lshlrev_b32 v32, 16, v48
    v_and_b32 v33, s30, v48
    v_sub_f32 v34, v34, v56
    v_sub_f32 v35, v35, v56
    v_cvt_pk_bf16_f32 v48, v34, v35
    v_lshlrev_b32 v34, 16, v48
    v_and_b32 v35, s30, v48
    v_sub_f32 v36, v36, v56
    v_sub_f32 v37, v37, v56
    v_cvt_pk_bf16_f32 v48, v36, v37
    v_lshlrev_b32 v36, 16, v48
    v_and_b32 v37, s30, v48
    v_sub_f32 v38, v38, v56
    v_sub_f32 v39, v39, v56
    v_cvt_pk_bf16_f32 v48, v38, v39
    v_lshlrev_b32 v38, 16, v48
    v_and_b32 v39, s30, v48
    v_sub_f32 v40, v40, v56
    v_sub_f32 v41, v41, v56
    v_cvt_pk_bf16_f32 v48, v40, v41
    v_lshlrev_b32 v40, 16, v48
    v_and_b32 v41, s30, v48
    v_sub_f32 v42, v42, v56
    v_sub_f32 v43, v43, v56
    v_cvt_pk_bf16_f32 v48, v42, v43
    v_lshlrev_b32 v42, 16, v48
    v_and_b32 v43, s30, v48
    v_sub_f32 v44, v44, v56
    v_sub_f32 v45, v45, v56
    v_cvt_pk_bf16_f32 v48, v44, v45
    v_lshlrev_b32 v44, 16, v48
    v_and_b32 v45, s30, v48
    v_sub_f32 v46, v46, v56
    v_sub_f32 v47, v47, v56
    v_cvt_pk_bf16_f32 v48, v46, v47
    v_lshlrev_b32 v46, 16, v48
    v_and_b32 v47, s30, v48
    v_mul_f32 v48, v32, v58
    v_fma_f32 v49, -v48, v57, v32
    v_fma_f32 v32, v49, v58, v48
    v_mul_f32 v50, v33, v58
    v_fma_f32 v51, -v50, v57, v33
    v_fma_f32 v33, v51, v58, v50
    v_mul_f32 v52, v34, v58
    v_fma_f32 v53, -v52, v57, v34
    v_fma_f32 v34, v53, v58, v52
    v_mul_f32 v54, v35, v58
    v_fma_f32 v55, -v54, v57, v35
    v_fma_f32 v35, v55, v58, v54
    v_mul_f32 v48, v36, v58
    v_fma_f32 v49, -v48, v57, v36
    v_fma_f32 v36, v49, v58, v48
    v_mul_f32 v50, v37, v58
    v_fma_f32 v51, -v50, v57, v37
    v_fma_f32 v37, v51, v58, v50
    v_mul_f32 v52, v38, v58
    v_fma_f32 v53, -v52, v57, v38
    v_fma_f32 v38, v53, v58, v52
    v_mul_f32 v54, v39, v58
    v_fma_f32 v55, -v54, v57, v39
    v_fma_f32 v39, v55, v58, v54
    v_mul_f32 v48, v40, v58
    v_fma_f32 v49, -v48, v57, v40
    v_fma_f32 v40, v49, v58, v48
    v_mul_f32 v50, v41, v58
    v_fma_f32 v51, -v50, v57, v41
    v_fma_f32 v41, v51, v58, v50
    v_mul_f32 v52, v42, v58
    v_fma_f32 v53, -v52, v57, v42
    v_fma_f32 v42, v53, v58, v52
    v_mul_f32 v54, v43, v58
    v_fma_f32 v55, -v54, v57, v43
    v_fma_f32 v43, v55, v58, v54
    v_mul_f32 v48, v44, v58
    v_fma_f32 v49, -v48, v57, v44
    v_fma_f32 v44, v49, v58, v48
    v_mul_f32 v50, v45, v58
    v_fma_f32 v51, -v50, v57, v45
    v_fma_f32 v45, v51, v58, v50
    v_mul_f32 v52, v46, v58
    v_fma_f32 v53, -v52, v57, v46
    v_fma_f32 v46, v53, v58, v52
    v_mul_f32 v54, v47, v58
    v_fma_f32 v55, -v54, v57, v47
    v_fma_f32 v47, v55, v58, v54
    v_cvt_pk_bf16_f32 v4, v32, v33
    v_cvt_pk_bf16_f32 v5, v34, v35
    v_cvt_pk_bf16_f32 v6, v36, v37
    v_cvt_pk_bf16_f32 v7, v38, v39
    v_cvt_pk_bf16_f32 v8, v40, v41
    v_cvt_pk_bf16_f32 v9, v42, v43
    v_cvt_pk_bf16_f32 v10, v44, v45
    v_cvt_pk_bf16_f32 v11, v46, v47
    buffer_store_dwordx4 v[4:7], v1, s[36:39], s3 offen sc1
    buffer_store_dwordx4 v[8:11], v1, s[36:39], s3 offen offset:1024 sc1
il_ln_first_kernel_end_1:
    s_endpgm
.globl il_ln_pq_kernel
.p2align 8
.type il_ln_pq_kernel,@function
il_ln_pq_kernel:
    s_cmp_ge_u32 s2, 512
    s_cbranch_scc1 il_ln_pq_kernel_end_1
    s_load_dwordx2 s[20:21], s[0:1], 88
    s_lshl_b32 s3, s2, 13
    v_lshlrev_b32 v1, 4, v0
    v_lshrrev_b32 v2, 6, v0
    v_lshl_add_u32 v1, v2, 10, v1
    s_waitcnt lgkmcnt(0)
    s_mov_b32 s4, s20
    s_mov_b32 s5, s21
    s_mov_b32 s6, 0x400000
    s_and_b32 s5, s5, 0xffff
    s_mov_b32 s7, 0x20000
    s_add_u32 s8, s20, 0x1000000
    s_addc_u32 s9, s21, 0
    s_mov_b32 s10, 0x400000
    s_and_b32 s9, s9, 0xffff
    s_mov_b32 s11, 0x20000
    s_add_u32 s12, s20, 0x1400000
    s_addc_u32 s13, s21, 0
    s_mov_b32 s14, 0x400000
    s_and_b32 s13, s13, 0xffff
    s_mov_b32 s15, 0x20000
    buffer_load_dwordx4 v[4:7], v1, s[4:7], s3 offen
    buffer_load_dwordx4 v[8:11], v1, s[4:7], s3 offen offset:1024
    buffer_load_dwordx4 v[12:15], v1, s[8:11], s3 offen
    buffer_load_dwordx4 v[16:19], v1, s[8:11], s3 offen offset:1024
    buffer_load_dwordx4 v[20:23], v1, s[12:15], s3 offen
    buffer_load_dwordx4 v[24:27], v1, s[12:15], s3 offen offset:1024
    s_mov_b32 s30, 0xffff0000
    s_mov_b32 s32, s20
    s_mov_b32 s33, s21
    s_mov_b32 s34, 0x400000
    s_and_b32 s33, s33, 0xffff
    s_mov_b32 s35, 0x20000
    s_add_u32 s36, s20, 0x400000
    s_addc_u32 s37, s21, 0
    s_mov_b32 s38, 0x400000
    s_and_b32 s37, s37, 0xffff
    s_mov_b32 s39, 0x20000
    s_waitcnt vmcnt(0)
    v_lshlrev_b32 v48, 16, v12
    v_lshlrev_b32 v49, 16, v20
    v_and_b32 v50, s30, v12
    v_and_b32 v51, s30, v20
    v_sub_f32 v48, v48, v49
    v_sub_f32 v50, v50, v51
    v_cvt_pk_bf16_f32 v12, v48, v50
    v_lshlrev_b32 v48, 16, v4
    v_lshlrev_b32 v49, 16, v12
    v_and_b32 v50, s30, v4
    v_and_b32 v51, s30, v12
    v_add_f32 v48, v48, v49
    v_add_f32 v50, v50, v51
    v_cvt_pk_bf16_f32 v4, v48, v50
    v_lshlrev_b32 v48, 16, v13
    v_lshlrev_b32 v49, 16, v21
    v_and_b32 v50, s30, v13
    v_and_b32 v51, s30, v21
    v_sub_f32 v48, v48, v49
    v_sub_f32 v50, v50, v51
    v_cvt_pk_bf16_f32 v13, v48, v50
    v_lshlrev_b32 v48, 16, v5
    v_lshlrev_b32 v49, 16, v13
    v_and_b32 v50, s30, v5
    v_and_b32 v51, s30, v13
    v_add_f32 v48, v48, v49
    v_add_f32 v50, v50, v51
    v_cvt_pk_bf16_f32 v5, v48, v50
    v_lshlrev_b32 v48, 16, v14
    v_lshlrev_b32 v49, 16, v22
    v_and_b32 v50, s30, v14
    v_and_b32 v51, s30, v22
    v_sub_f32 v48, v48, v49
    v_sub_f32 v50, v50, v51
    v_cvt_pk_bf16_f32 v14, v48, v50
    v_lshlrev_b32 v48, 16, v6
    v_lshlrev_b32 v49, 16, v14
    v_and_b32 v50, s30, v6
    v_and_b32 v51, s30, v14
    v_add_f32 v48, v48, v49
    v_add_f32 v50, v50, v51
    v_cvt_pk_bf16_f32 v6, v48, v50
    v_lshlrev_b32 v48, 16, v15
    v_lshlrev_b32 v49, 16, v23
    v_and_b32 v50, s30, v15
    v_and_b32 v51, s30, v23
    v_sub_f32 v48, v48, v49
    v_sub_f32 v50, v50, v51
    v_cvt_pk_bf16_f32 v15, v48, v50
    v_lshlrev_b32 v48, 16, v7
    v_lshlrev_b32 v49, 16, v15
    v_and_b32 v50, s30, v7
    v_and_b32 v51, s30, v15
    v_add_f32 v48, v48, v49
    v_add_f32 v50, v50, v51
    v_cvt_pk_bf16_f32 v7, v48, v50
    v_lshlrev_b32 v48, 16, v16
    v_lshlrev_b32 v49, 16, v24
    v_and_b32 v50, s30, v16
    v_and_b32 v51, s30, v24
    v_sub_f32 v48, v48, v49
    v_sub_f32 v50, v50, v51
    v_cvt_pk_bf16_f32 v16, v48, v50
    v_lshlrev_b32 v48, 16, v8
    v_lshlrev_b32 v49, 16, v16
    v_and_b32 v50, s30, v8
    v_and_b32 v51, s30, v16
    v_add_f32 v48, v48, v49
    v_add_f32 v50, v50, v51
    v_cvt_pk_bf16_f32 v8, v48, v50
    v_lshlrev_b32 v48, 16, v17
    v_lshlrev_b32 v49, 16, v25
    v_and_b32 v50, s30, v17
    v_and_b32 v51, s30, v25
    v_sub_f32 v48, v48, v49
    v_sub_f32 v50, v50, v51
    v_cvt_pk_bf16_f32 v17, v48, v50
    v_lshlrev_b32 v48, 16, v9
    v_lshlrev_b32 v49, 16, v17
    v_and_b32 v50, s30, v9
    v_and_b32 v51, s30, v17
    v_add_f32 v48, v48, v49
    v_add_f32 v50, v50, v51
    v_cvt_pk_bf16_f32 v9, v48, v50
    v_lshlrev_b32 v48, 16, v18
    v_lshlrev_b32 v49, 16, v26
    v_and_b32 v50, s30, v18
    v_and_b32 v51, s30, v26
    v_sub_f32 v48, v48, v49
    v_sub_f32 v50, v50, v51
    v_cvt_pk_bf16_f32 v18, v48, v50
    v_lshlrev_b32 v48, 16, v10
    v_lshlrev_b32 v49, 16, v18
    v_and_b32 v50, s30, v10
    v_and_b32 v51, s30, v18
    v_add_f32 v48, v48, v49
    v_add_f32 v50, v50, v51
    v_cvt_pk_bf16_f32 v10, v48, v50
    v_lshlrev_b32 v48, 16, v19
    v_lshlrev_b32 v49, 16, v27
    v_and_b32 v50, s30, v19
    v_and_b32 v51, s30, v27
    v_sub_f32 v48, v48, v49
    v_sub_f32 v50, v50, v51
    v_cvt_pk_bf16_f32 v19, v48, v50
    v_lshlrev_b32 v48, 16, v11
    v_lshlrev_b32 v49, 16, v19
    v_and_b32 v50, s30, v11
    v_and_b32 v51, s30, v19
    v_add_f32 v48, v48, v49
    v_add_f32 v50, v50, v51
    v_cvt_pk_bf16_f32 v11, v48, v50
    buffer_store_dwordx4 v[4:7], v1, s[32:35], s3 offen sc1
    buffer_store_dwordx4 v[8:11], v1, s[32:35], s3 offen offset:1024 sc1
    v_lshlrev_b32 v32, 16, v4
    v_and_b32 v33, s30, v4
    v_lshlrev_b32 v34, 16, v5
    v_and_b32 v35, s30, v5
    v_lshlrev_b32 v36, 16, v6
    v_and_b32 v37, s30, v6
    v_lshlrev_b32 v38, 16, v7
    v_and_b32 v39, s30, v7
    v_lshlrev_b32 v40, 16, v8
    v_and_b32 v41, s30, v8
    v_lshlrev_b32 v42, 16, v9
    v_and_b32 v43, s30, v9
    v_lshlrev_b32 v44, 16, v10
    v_and_b32 v45, s30, v10
    v_lshlrev_b32 v46, 16, v11
    v_and_b32 v47, s30, v11
    v_add_f32 v56, v32, v33
    v_add_f32 v56, v56, v34
    v_add_f32 v56, v56, v35
    v_add_f32 v56, v56, v36
    v_add_f32 v56, v56, v37
    v_add_f32 v56, v56, v38
    v_add_f32 v56, v56, v39
    v_add_f32 v56, v56, v40
    v_add_f32 v56, v56, v41
    v_add_f32 v56, v56, v42
    v_add_f32 v56, v56, v43
    v_add_f32 v56, v56, v44
    v_add_f32 v56, v56, v45
    v_add_f32 v56, v56, v46
    v_add_f32 v56, v56, v47
    s_nop 1
    v_add_f32_dpp v56, v56, v56 quad_perm:[1,0,3,2] row_mask:0xf bank_mask:0xf
    s_nop 1
    v_add_f32_dpp v56, v56, v56 quad_perm:[2,3,0,1] row_mask:0xf bank_mask:0xf
    s_nop 1
    v_add_f32_dpp v56, v56, v56 row_half_mirror row_mask:0xf bank_mask:0xf
    s_nop 1
    v_add_f32_dpp v56, v56, v56 row_mirror row_mask:0xf bank_mask:0xf
    s_nop 1
    v_readlane_b32 s40, v56, 0
    v_readlane_b32 s41, v56, 16
    v_readlane_b32 s42, v56, 32
    v_readlane_b32 s43, v56, 48
    s_nop 3
    v_mov_b32 v56, s40
    v_add_f32 v56, s41, v56
    v_add_f32 v56, s42, v56
    v_add_f32 v56, s43, v56
    v_mul_f32 v56, 0x3a800000, v56
    v_sub_f32 v48, v32, v56
    v_mul_f32 v57, v48, v48
    v_sub_f32 v48, v33, v56
    v_fmac_f32 v57, v48, v48
    v_sub_f32 v48, v34, v56
    v_fmac_f32 v57, v48, v48
    v_sub_f32 v48, v35, v56
    v_fmac_f32 v57, v48, v48
    v_sub_f32 v48, v36, v56
    v_fmac_f32 v57, v48, v48
    v_sub_f32 v48, v37, v56
    v_fmac_f32 v57, v48, v48
    v_sub_f32 v48, v38, v56
    v_fmac_f32 v57, v48, v48
    v_sub_f32 v48, v39, v56
    v_fmac_f32 v57, v48, v48
    v_sub_f32 v48, v40, v56
    v_fmac_f32 v57, v48, v48
    v_sub_f32 v48, v41, v56
    v_fmac_f32 v57, v48, v48
    v_sub_f32 v48, v42, v56
    v_fmac_f32 v57, v48, v48
    v_sub_f32 v48, v43, v56
    v_fmac_f32 v57, v48, v48
    v_sub_f32 v48, v44, v56
    v_fmac_f32 v57, v48, v48
    v_sub_f32 v48, v45, v56
    v_fmac_f32 v57, v48, v48
    v_sub_f32 v48, v46, v56
    v_fmac_f32 v57, v48, v48
    v_sub_f32 v48, v47, v56
    v_fmac_f32 v57, v48, v48
    s_nop 1
    v_add_f32_dpp v57, v57, v57 quad_perm:[1,0,3,2] row_mask:0xf bank_mask:0xf
    s_nop 1
    v_add_f32_dpp v57, v57, v57 quad_perm:[2,3,0,1] row_mask:0xf bank_mask:0xf
    s_nop 1
    v_add_f32_dpp v57, v57, v57 row_half_mirror row_mask:0xf bank_mask:0xf
    s_nop 1
    v_add_f32_dpp v57, v57, v57 row_mirror row_mask:0xf bank_mask:0xf
    s_nop 1
    v_readlane_b32 s40, v57, 0
    v_readlane_b32 s41, v57, 16
    v_readlane_b32 s42, v57, 32
    v_readlane_b32 s43, v57, 48
    s_nop 3
    v_mov_b32 v57, s40
    v_add_f32 v57, s41, v57
    v_add_f32 v57, s42, v57
    v_add_f32 v57, s43, v57
    v_mul_f32 v57, 0x3a800000, v57
    v_cvt_pk_bf16_f32 v56, v56, v57
    v_and_b32 v57, s30, v56
    v_lshlrev_b32 v56, 16, v56
    v_add_f32 v57, 0x3727c5ac, v57
    v_cvt_pk_bf16_f32 v57, v57, v57
    v_lshlrev_b32 v57, 16, v57
    v_sqrt_f32 v57, v57
    s_nop 0
    v_cvt_pk_bf16_f32 v57, v57, v57
    v_lshlrev_b32 v57, 16, v57
    v_rcp_f32 v58, v57
    v_sub_f32 v32, v32, v56
    v_sub_f32 v33, v33, v56
    v_cvt_pk_bf16_f32 v48, v32, v33
    v_lshlrev_b32 v32, 16, v48
    v_and_b32 v33, s30, v48
    v_sub_f32 v34, v34, v56
    v_sub_f32 v35, v35, v56
    v_cvt_pk_bf16_f32 v48, v34, v35
    v_lshlrev_b32 v34, 16, v48
    v_and_b32 v35, s30, v48
    v_sub_f32 v36, v36, v56
    v_sub_f32 v37, v37, v56
    v_cvt_pk_bf16_f32 v48, v36, v37
    v_lshlrev_b32 v36, 16, v48
    v_and_b32 v37, s30, v48
    v_sub_f32 v38, v38, v56
    v_sub_f32 v39, v39, v56
    v_cvt_pk_bf16_f32 v48, v38, v39
    v_lshlrev_b32 v38, 16, v48
    v_and_b32 v39, s30, v48
    v_sub_f32 v40, v40, v56
    v_sub_f32 v41, v41, v56
    v_cvt_pk_bf16_f32 v48, v40, v41
    v_lshlrev_b32 v40, 16, v48
    v_and_b32 v41, s30, v48
    v_sub_f32 v42, v42, v56
    v_sub_f32 v43, v43, v56
    v_cvt_pk_bf16_f32 v48, v42, v43
    v_lshlrev_b32 v42, 16, v48
    v_and_b32 v43, s30, v48
    v_sub_f32 v44, v44, v56
    v_sub_f32 v45, v45, v56
    v_cvt_pk_bf16_f32 v48, v44, v45
    v_lshlrev_b32 v44, 16, v48
    v_and_b32 v45, s30, v48
    v_sub_f32 v46, v46, v56
    v_sub_f32 v47, v47, v56
    v_cvt_pk_bf16_f32 v48, v46, v47
    v_lshlrev_b32 v46, 16, v48
    v_and_b32 v47, s30, v48
    v_mul_f32 v48, v32, v58
    v_fma_f32 v49, -v48, v57, v32
    v_fma_f32 v32, v49, v58, v48
    v_mul_f32 v50, v33, v58
    v_fma_f32 v51, -v50, v57, v33
    v_fma_f32 v33, v51, v58, v50
    v_mul_f32 v52, v34, v58
    v_fma_f32 v53, -v52, v57, v34
    v_fma_f32 v34, v53, v58, v52
    v_mul_f32 v54, v35, v58
    v_fma_f32 v55, -v54, v57, v35
    v_fma_f32 v35, v55, v58, v54
    v_mul_f32 v48, v36, v58
    v_fma_f32 v49, -v48, v57, v36
    v_fma_f32 v36, v49, v58, v48
    v_mul_f32 v50, v37, v58
    v_fma_f32 v51, -v50, v57, v37
    v_fma_f32 v37, v51, v58, v50
    v_mul_f32 v52, v38, v58
    v_fma_f32 v53, -v52, v57, v38
    v_fma_f32 v38, v53, v58, v52
    v_mul_f32 v54, v39, v58
    v_fma_f32 v55, -v54, v57, v39
    v_fma_f32 v39, v55, v58, v54
    v_mul_f32 v48, v40, v58
    v_fma_f32 v49, -v48, v57, v40
    v_fma_f32 v40, v49, v58, v48
    v_mul_f32 v50, v41, v58
    v_fma_f32 v51, -v50, v57, v41
    v_fma_f32 v41, v51, v58, v50
    v_mul_f32 v52, v42, v58
    v_fma_f32 v53, -v52, v57, v42
    v_fma_f32 v42, v53, v58, v52
    v_mul_f32 v54, v43, v58
    v_fma_f32 v55, -v54, v57, v43
    v_fma_f32 v43, v55, v58, v54
    v_mul_f32 v48, v44, v58
    v_fma_f32 v49, -v48, v57, v44
    v_fma_f32 v44, v49, v58, v48
    v_mul_f32 v50, v45, v58
    v_fma_f32 v51, -v50, v57, v45
    v_fma_f32 v45, v51, v58, v50
    v_mul_f32 v52, v46, v58
    v_fma_f32 v53, -v52, v57, v46
    v_fma_f32 v46, v53, v58, v52
    v_mul_f32 v54, v47, v58
    v_fma_f32 v55, -v54, v57, v47
    v_fma_f32 v47, v55, v58, v54
    v_cvt_pk_bf16_f32 v4, v32, v33
    v_cvt_pk_bf16_f32 v5, v34, v35
    v_cvt_pk_bf16_f32 v6, v36, v37
    v_cvt_pk_bf16_f32 v7, v38, v39
    v_cvt_pk_bf16_f32 v8, v40, v41
    v_cvt_pk_bf16_f32 v9, v42, v43
    v_cvt_pk_bf16_f32 v10, v44, v45
    v_cvt_pk_bf16_f32 v11, v46, v47
    buffer_store_dwordx4 v[4:7], v1, s[36:39], s3 offen sc1
    buffer_store_dwordx4 v[8:11], v1, s[36:39], s3 offen offset:1024 sc1
il_ln_pq_kernel_end_1:
    s_endpgm
.globl il_ln_o_kernel
.p2align 8
.type il_ln_o_kernel,@function
il_ln_o_kernel:
    s_cmp_ge_u32 s2, 512
    s_cbranch_scc1 il_ln_o_kernel_end_1
    s_load_dwordx2 s[20:21], s[0:1], 88
    s_lshl_b32 s3, s2, 13
    v_lshlrev_b32 v1, 4, v0
    v_lshrrev_b32 v2, 6, v0
    v_lshl_add_u32 v1, v2, 10, v1
    s_waitcnt lgkmcnt(0)
    s_mov_b32 s4, s20
    s_mov_b32 s5, s21
    s_mov_b32 s6, 0x400000
    s_and_b32 s5, s5, 0xffff
    s_mov_b32 s7, 0x20000
    s_add_u32 s8, s20, 0x2800000
    s_addc_u32 s9, s21, 0
    s_mov_b32 s10, 0x800000
    s_and_b32 s9, s9, 0xffff
    s_mov_b32 s11, 0x20000
    s_add_u32 s12, s20, 0x3000000
    s_addc_u32 s13, s21, 0
    s_mov_b32 s14, 0x800000
    s_and_b32 s13, s13, 0xffff
    s_mov_b32 s15, 0x20000
    buffer_load_dwordx4 v[4:7], v1, s[4:7], s3 offen
    buffer_load_dwordx4 v[8:11], v1, s[4:7], s3 offen offset:1024
    s_lshl_b32 s31, s3, 1
    v_lshlrev_b32 v3, 1, v1
    buffer_load_dwordx4 v[64:67], v3, s[8:11], s31 offen offset:0
    buffer_load_dwordx4 v[68:71], v3, s[8:11], s31 offen offset:16
    buffer_load_dwordx4 v[72:75], v3, s[8:11], s31 offen offset:2048
    buffer_load_dwordx4 v[76:79], v3, s[8:11], s31 offen offset:2064
    buffer_load_dwordx4 v[80:83], v3, s[12:15], s31 offen offset:0
    buffer_load_dwordx4 v[84:87], v3, s[12:15], s31 offen offset:16
    buffer_load_dwordx4 v[88:91], v3, s[12:15], s31 offen offset:2048
    buffer_load_dwordx4 v[92:95], v3, s[12:15], s31 offen offset:2064
    s_mov_b32 s30, 0xffff0000
    s_mov_b32 s32, s20
    s_mov_b32 s33, s21
    s_mov_b32 s34, 0x400000
    s_and_b32 s33, s33, 0xffff
    s_mov_b32 s35, 0x20000
    s_add_u32 s36, s20, 0x400000
    s_addc_u32 s37, s21, 0
    s_mov_b32 s38, 0x400000
    s_and_b32 s37, s37, 0xffff
    s_mov_b32 s39, 0x20000
    s_waitcnt vmcnt(0)
    v_add_f32 v64, v64, v80
    v_add_f32 v65, v65, v81
    v_add_f32 v66, v66, v82
    v_add_f32 v67, v67, v83
    v_add_f32 v68, v68, v84
    v_add_f32 v69, v69, v85
    v_add_f32 v70, v70, v86
    v_add_f32 v71, v71, v87
    v_add_f32 v72, v72, v88
    v_add_f32 v73, v73, v89
    v_add_f32 v74, v74, v90
    v_add_f32 v75, v75, v91
    v_add_f32 v76, v76, v92
    v_add_f32 v77, v77, v93
    v_add_f32 v78, v78, v94
    v_add_f32 v79, v79, v95
    v_cvt_pk_bf16_f32 v12, v64, v65
    v_cvt_pk_bf16_f32 v13, v66, v67
    v_cvt_pk_bf16_f32 v14, v68, v69
    v_cvt_pk_bf16_f32 v15, v70, v71
    v_cvt_pk_bf16_f32 v16, v72, v73
    v_cvt_pk_bf16_f32 v17, v74, v75
    v_cvt_pk_bf16_f32 v18, v76, v77
    v_cvt_pk_bf16_f32 v19, v78, v79
    v_lshlrev_b32 v48, 16, v4
    v_lshlrev_b32 v49, 16, v12
    v_and_b32 v50, s30, v4
    v_and_b32 v51, s30, v12
    v_add_f32 v48, v48, v49
    v_add_f32 v50, v50, v51
    v_cvt_pk_bf16_f32 v4, v48, v50
    v_lshlrev_b32 v48, 16, v5
    v_lshlrev_b32 v49, 16, v13
    v_and_b32 v50, s30, v5
    v_and_b32 v51, s30, v13
    v_add_f32 v48, v48, v49
    v_add_f32 v50, v50, v51
    v_cvt_pk_bf16_f32 v5, v48, v50
    v_lshlrev_b32 v48, 16, v6
    v_lshlrev_b32 v49, 16, v14
    v_and_b32 v50, s30, v6
    v_and_b32 v51, s30, v14
    v_add_f32 v48, v48, v49
    v_add_f32 v50, v50, v51
    v_cvt_pk_bf16_f32 v6, v48, v50
    v_lshlrev_b32 v48, 16, v7
    v_lshlrev_b32 v49, 16, v15
    v_and_b32 v50, s30, v7
    v_and_b32 v51, s30, v15
    v_add_f32 v48, v48, v49
    v_add_f32 v50, v50, v51
    v_cvt_pk_bf16_f32 v7, v48, v50
    v_lshlrev_b32 v48, 16, v8
    v_lshlrev_b32 v49, 16, v16
    v_and_b32 v50, s30, v8
    v_and_b32 v51, s30, v16
    v_add_f32 v48, v48, v49
    v_add_f32 v50, v50, v51
    v_cvt_pk_bf16_f32 v8, v48, v50
    v_lshlrev_b32 v48, 16, v9
    v_lshlrev_b32 v49, 16, v17
    v_and_b32 v50, s30, v9
    v_and_b32 v51, s30, v17
    v_add_f32 v48, v48, v49
    v_add_f32 v50, v50, v51
    v_cvt_pk_bf16_f32 v9, v48, v50
    v_lshlrev_b32 v48, 16, v10
    v_lshlrev_b32 v49, 16, v18
    v_and_b32 v50, s30, v10
    v_and_b32 v51, s30, v18
    v_add_f32 v48, v48, v49
    v_add_f32 v50, v50, v51
    v_cvt_pk_bf16_f32 v10, v48, v50
    v_lshlrev_b32 v48, 16, v11
    v_lshlrev_b32 v49, 16, v19
    v_and_b32 v50, s30, v11
    v_and_b32 v51, s30, v19
    v_add_f32 v48, v48, v49
    v_add_f32 v50, v50, v51
    v_cvt_pk_bf16_f32 v11, v48, v50
    buffer_store_dwordx4 v[4:7], v1, s[32:35], s3 offen sc1
    buffer_store_dwordx4 v[8:11], v1, s[32:35], s3 offen offset:1024 sc1
    v_lshlrev_b32 v32, 16, v4
    v_and_b32 v33, s30, v4
    v_lshlrev_b32 v34, 16, v5
    v_and_b32 v35, s30, v5
    v_lshlrev_b32 v36, 16, v6
    v_and_b32 v37, s30, v6
    v_lshlrev_b32 v38, 16, v7
    v_and_b32 v39, s30, v7
    v_lshlrev_b32 v40, 16, v8
    v_and_b32 v41, s30, v8
    v_lshlrev_b32 v42, 16, v9
    v_and_b32 v43, s30, v9
    v_lshlrev_b32 v44, 16, v10
    v_and_b32 v45, s30, v10
    v_lshlrev_b32 v46, 16, v11
    v_and_b32 v47, s30, v11
    v_add_f32 v56, v32, v33
    v_add_f32 v56, v56, v34
    v_add_f32 v56, v56, v35
    v_add_f32 v56, v56, v36
    v_add_f32 v56, v56, v37
    v_add_f32 v56, v56, v38
    v_add_f32 v56, v56, v39
    v_add_f32 v56, v56, v40
    v_add_f32 v56, v56, v41
    v_add_f32 v56, v56, v42
    v_add_f32 v56, v56, v43
    v_add_f32 v56, v56, v44
    v_add_f32 v56, v56, v45
    v_add_f32 v56, v56, v46
    v_add_f32 v56, v56, v47
    s_nop 1
    v_add_f32_dpp v56, v56, v56 quad_perm:[1,0,3,2] row_mask:0xf bank_mask:0xf
    s_nop 1
    v_add_f32_dpp v56, v56, v56 quad_perm:[2,3,0,1] row_mask:0xf bank_mask:0xf
    s_nop 1
    v_add_f32_dpp v56, v56, v56 row_half_mirror row_mask:0xf bank_mask:0xf
    s_nop 1
    v_add_f32_dpp v56, v56, v56 row_mirror row_mask:0xf bank_mask:0xf
    s_nop 1
    v_readlane_b32 s40, v56, 0
    v_readlane_b32 s41, v56, 16
    v_readlane_b32 s42, v56, 32
    v_readlane_b32 s43, v56, 48
    s_nop 3
    v_mov_b32 v56, s40
    v_add_f32 v56, s41, v56
    v_add_f32 v56, s42, v56
    v_add_f32 v56, s43, v56
    v_mul_f32 v56, 0x3a800000, v56
    v_sub_f32 v48, v32, v56
    v_mul_f32 v57, v48, v48
    v_sub_f32 v48, v33, v56
    v_fmac_f32 v57, v48, v48
    v_sub_f32 v48, v34, v56
    v_fmac_f32 v57, v48, v48
    v_sub_f32 v48, v35, v56
    v_fmac_f32 v57, v48, v48
    v_sub_f32 v48, v36, v56
    v_fmac_f32 v57, v48, v48
    v_sub_f32 v48, v37, v56
    v_fmac_f32 v57, v48, v48
    v_sub_f32 v48, v38, v56
    v_fmac_f32 v57, v48, v48
    v_sub_f32 v48, v39, v56
    v_fmac_f32 v57, v48, v48
    v_sub_f32 v48, v40, v56
    v_fmac_f32 v57, v48, v48
    v_sub_f32 v48, v41, v56
    v_fmac_f32 v57, v48, v48
    v_sub_f32 v48, v42, v56
    v_fmac_f32 v57, v48, v48
    v_sub_f32 v48, v43, v56
    v_fmac_f32 v57, v48, v48
    v_sub_f32 v48, v44, v56
    v_fmac_f32 v57, v48, v48
    v_sub_f32 v48, v45, v56
    v_fmac_f32 v57, v48, v48
    v_sub_f32 v48, v46, v56
    v_fmac_f32 v57, v48, v48
    v_sub_f32 v48, v47, v56
    v_fmac_f32 v57, v48, v48
    s_nop 1
    v_add_f32_dpp v57, v57, v57 quad_perm:[1,0,3,2] row_mask:0xf bank_mask:0xf
    s_nop 1
    v_add_f32_dpp v57, v57, v57 quad_perm:[2,3,0,1] row_mask:0xf bank_mask:0xf
    s_nop 1
    v_add_f32_dpp v57, v57, v57 row_half_mirror row_mask:0xf bank_mask:0xf
    s_nop 1
    v_add_f32_dpp v57, v57, v57 row_mirror row_mask:0xf bank_mask:0xf
    s_nop 1
    v_readlane_b32 s40, v57, 0
    v_readlane_b32 s41, v57, 16
    v_readlane_b32 s42, v57, 32
    v_readlane_b32 s43, v57, 48
    s_nop 3
    v_mov_b32 v57, s40
    v_add_f32 v57, s41, v57
    v_add_f32 v57, s42, v57
    v_add_f32 v57, s43, v57
    v_mul_f32 v57, 0x3a800000, v57
    v_cvt_pk_bf16_f32 v56, v56, v57
    v_and_b32 v57, s30, v56
    v_lshlrev_b32 v56, 16, v56
    v_add_f32 v57, 0x3727c5ac, v57
    v_cvt_pk_bf16_f32 v57, v57, v57
    v_lshlrev_b32 v57, 16, v57
    v_sqrt_f32 v57, v57
    s_nop 0
    v_cvt_pk_bf16_f32 v57, v57, v57
    v_lshlrev_b32 v57, 16, v57
    v_rcp_f32 v58, v57
    v_sub_f32 v32, v32, v56
    v_sub_f32 v33, v33, v56
    v_cvt_pk_bf16_f32 v48, v32, v33
    v_lshlrev_b32 v32, 16, v48
    v_and_b32 v33, s30, v48
    v_sub_f32 v34, v34, v56
    v_sub_f32 v35, v35, v56
    v_cvt_pk_bf16_f32 v48, v34, v35
    v_lshlrev_b32 v34, 16, v48
    v_and_b32 v35, s30, v48
    v_sub_f32 v36, v36, v56
    v_sub_f32 v37, v37, v56
    v_cvt_pk_bf16_f32 v48, v36, v37
    v_lshlrev_b32 v36, 16, v48
    v_and_b32 v37, s30, v48
    v_sub_f32 v38, v38, v56
    v_sub_f32 v39, v39, v56
    v_cvt_pk_bf16_f32 v48, v38, v39
    v_lshlrev_b32 v38, 16, v48
    v_and_b32 v39, s30, v48
    v_sub_f32 v40, v40, v56
    v_sub_f32 v41, v41, v56
    v_cvt_pk_bf16_f32 v48, v40, v41
    v_lshlrev_b32 v40, 16, v48
    v_and_b32 v41, s30, v48
    v_sub_f32 v42, v42, v56
    v_sub_f32 v43, v43, v56
    v_cvt_pk_bf16_f32 v48, v42, v43
    v_lshlrev_b32 v42, 16, v48
    v_and_b32 v43, s30, v48
    v_sub_f32 v44, v44, v56
    v_sub_f32 v45, v45, v56
    v_cvt_pk_bf16_f32 v48, v44, v45
    v_lshlrev_b32 v44, 16, v48
    v_and_b32 v45, s30, v48
    v_sub_f32 v46, v46, v56
    v_sub_f32 v47, v47, v56
    v_cvt_pk_bf16_f32 v48, v46, v47
    v_lshlrev_b32 v46, 16, v48
    v_and_b32 v47, s30, v48
    v_mul_f32 v48, v32, v58
    v_fma_f32 v49, -v48, v57, v32
    v_fma_f32 v32, v49, v58, v48
    v_mul_f32 v50, v33, v58
    v_fma_f32 v51, -v50, v57, v33
    v_fma_f32 v33, v51, v58, v50
    v_mul_f32 v52, v34, v58
    v_fma_f32 v53, -v52, v57, v34
    v_fma_f32 v34, v53, v58, v52
    v_mul_f32 v54, v35, v58
    v_fma_f32 v55, -v54, v57, v35
    v_fma_f32 v35, v55, v58, v54
    v_mul_f32 v48, v36, v58
    v_fma_f32 v49, -v48, v57, v36
    v_fma_f32 v36, v49, v58, v48
    v_mul_f32 v50, v37, v58
    v_fma_f32 v51, -v50, v57, v37
    v_fma_f32 v37, v51, v58, v50
    v_mul_f32 v52, v38, v58
    v_fma_f32 v53, -v52, v57, v38
    v_fma_f32 v38, v53, v58, v52
    v_mul_f32 v54, v39, v58
    v_fma_f32 v55, -v54, v57, v39
    v_fma_f32 v39, v55, v58, v54
    v_mul_f32 v48, v40, v58
    v_fma_f32 v49, -v48, v57, v40
    v_fma_f32 v40, v49, v58, v48
    v_mul_f32 v50, v41, v58
    v_fma_f32 v51, -v50, v57, v41
    v_fma_f32 v41, v51, v58, v50
    v_mul_f32 v52, v42, v58
    v_fma_f32 v53, -v52, v57, v42
    v_fma_f32 v42, v53, v58, v52
    v_mul_f32 v54, v43, v58
    v_fma_f32 v55, -v54, v57, v43
    v_fma_f32 v43, v55, v58, v54
    v_mul_f32 v48, v44, v58
    v_fma_f32 v49, -v48, v57, v44
    v_fma_f32 v44, v49, v58, v48
    v_mul_f32 v50, v45, v58
    v_fma_f32 v51, -v50, v57, v45
    v_fma_f32 v45, v51, v58, v50
    v_mul_f32 v52, v46, v58
    v_fma_f32 v53, -v52, v57, v46
    v_fma_f32 v46, v53, v58, v52
    v_mul_f32 v54, v47, v58
    v_fma_f32 v55, -v54, v57, v47
    v_fma_f32 v47, v55, v58, v54
    v_cvt_pk_bf16_f32 v4, v32, v33
    v_cvt_pk_bf16_f32 v5, v34, v35
    v_cvt_pk_bf16_f32 v6, v36, v37
    v_cvt_pk_bf16_f32 v7, v38, v39
    v_cvt_pk_bf16_f32 v8, v40, v41
    v_cvt_pk_bf16_f32 v9, v42, v43
    v_cvt_pk_bf16_f32 v10, v44, v45
    v_cvt_pk_bf16_f32 v11, v46, v47
    buffer_store_dwordx4 v[4:7], v1, s[36:39], s3 offen sc1
    buffer_store_dwordx4 v[8:11], v1, s[36:39], s3 offen offset:1024 sc1
il_ln_o_kernel_end_1:
    s_endpgm
.globl il_ln_final_kernel
.p2align 8
.type il_ln_final_kernel,@function
il_ln_final_kernel:
    s_cmp_ge_u32 s2, 512
    s_cbranch_scc1 il_ln_final_kernel_end_1
    s_load_dwordx2 s[20:21], s[0:1], 88
    s_load_dwordx2 s[24:25], s[0:1], 72
    s_lshl_b32 s3, s2, 13
    v_lshlrev_b32 v1, 4, v0
    v_lshrrev_b32 v2, 6, v0
    v_lshl_add_u32 v1, v2, 10, v1
    s_waitcnt lgkmcnt(0)
    s_mov_b32 s4, s20
    s_mov_b32 s5, s21
    s_mov_b32 s6, 0x400000
    s_and_b32 s5, s5, 0xffff
    s_mov_b32 s7, 0x20000
    s_add_u32 s8, s20, 0x2800000
    s_addc_u32 s9, s21, 0
    s_mov_b32 s10, 0x800000
    s_and_b32 s9, s9, 0xffff
    s_mov_b32 s11, 0x20000
    s_add_u32 s12, s20, 0x3000000
    s_addc_u32 s13, s21, 0
    s_mov_b32 s14, 0x800000
    s_and_b32 s13, s13, 0xffff
    s_mov_b32 s15, 0x20000
    buffer_load_dwordx4 v[4:7], v1, s[4:7], s3 offen
    buffer_load_dwordx4 v[8:11], v1, s[4:7], s3 offen offset:1024
    s_lshl_b32 s31, s3, 1
    v_lshlrev_b32 v3, 1, v1
    buffer_load_dwordx4 v[64:67], v3, s[8:11], s31 offen offset:0
    buffer_load_dwordx4 v[68:71], v3, s[8:11], s31 offen offset:16
    buffer_load_dwordx4 v[72:75], v3, s[8:11], s31 offen offset:2048
    buffer_load_dwordx4 v[76:79], v3, s[8:11], s31 offen offset:2064
    buffer_load_dwordx4 v[80:83], v3, s[12:15], s31 offen offset:0
    buffer_load_dwordx4 v[84:87], v3, s[12:15], s31 offen offset:16
    buffer_load_dwordx4 v[88:91], v3, s[12:15], s31 offen offset:2048
    buffer_load_dwordx4 v[92:95], v3, s[12:15], s31 offen offset:2064
    s_mov_b32 s30, 0xffff0000
    s_mov_b32 s32, s24
    s_mov_b32 s33, s25
    s_mov_b32 s34, 0x400000
    s_and_b32 s33, s33, 0xffff
    s_mov_b32 s35, 0x20000
    s_waitcnt vmcnt(0)
    v_add_f32 v64, v64, v80
    v_add_f32 v65, v65, v81
    v_add_f32 v66, v66, v82
    v_add_f32 v67, v67, v83
    v_add_f32 v68, v68, v84
    v_add_f32 v69, v69, v85
    v_add_f32 v70, v70, v86
    v_add_f32 v71, v71, v87
    v_add_f32 v72, v72, v88
    v_add_f32 v73, v73, v89
    v_add_f32 v74, v74, v90
    v_add_f32 v75, v75, v91
    v_add_f32 v76, v76, v92
    v_add_f32 v77, v77, v93
    v_add_f32 v78, v78, v94
    v_add_f32 v79, v79, v95
    v_cvt_pk_bf16_f32 v12, v64, v65
    v_cvt_pk_bf16_f32 v13, v66, v67
    v_cvt_pk_bf16_f32 v14, v68, v69
    v_cvt_pk_bf16_f32 v15, v70, v71
    v_cvt_pk_bf16_f32 v16, v72, v73
    v_cvt_pk_bf16_f32 v17, v74, v75
    v_cvt_pk_bf16_f32 v18, v76, v77
    v_cvt_pk_bf16_f32 v19, v78, v79
    v_lshlrev_b32 v48, 16, v4
    v_lshlrev_b32 v49, 16, v12
    v_and_b32 v50, s30, v4
    v_and_b32 v51, s30, v12
    v_add_f32 v48, v48, v49
    v_add_f32 v50, v50, v51
    v_cvt_pk_bf16_f32 v4, v48, v50
    v_lshlrev_b32 v48, 16, v5
    v_lshlrev_b32 v49, 16, v13
    v_and_b32 v50, s30, v5
    v_and_b32 v51, s30, v13
    v_add_f32 v48, v48, v49
    v_add_f32 v50, v50, v51
    v_cvt_pk_bf16_f32 v5, v48, v50
    v_lshlrev_b32 v48, 16, v6
    v_lshlrev_b32 v49, 16, v14
    v_and_b32 v50, s30, v6
    v_and_b32 v51, s30, v14
    v_add_f32 v48, v48, v49
    v_add_f32 v50, v50, v51
    v_cvt_pk_bf16_f32 v6, v48, v50
    v_lshlrev_b32 v48, 16, v7
    v_lshlrev_b32 v49, 16, v15
    v_and_b32 v50, s30, v7
    v_and_b32 v51, s30, v15
    v_add_f32 v48, v48, v49
    v_add_f32 v50, v50, v51
    v_cvt_pk_bf16_f32 v7, v48, v50
    v_lshlrev_b32 v48, 16, v8
    v_lshlrev_b32 v49, 16, v16
    v_and_b32 v50, s30, v8
    v_and_b32 v51, s30, v16
    v_add_f32 v48, v48, v49
    v_add_f32 v50, v50, v51
    v_cvt_pk_bf16_f32 v8, v48, v50
    v_lshlrev_b32 v48, 16, v9
    v_lshlrev_b32 v49, 16, v17
    v_and_b32 v50, s30, v9
    v_and_b32 v51, s30, v17
    v_add_f32 v48, v48, v49
    v_add_f32 v50, v50, v51
    v_cvt_pk_bf16_f32 v9, v48, v50
    v_lshlrev_b32 v48, 16, v10
    v_lshlrev_b32 v49, 16, v18
    v_and_b32 v50, s30, v10
    v_and_b32 v51, s30, v18
    v_add_f32 v48, v48, v49
    v_add_f32 v50, v50, v51
    v_cvt_pk_bf16_f32 v10, v48, v50
    v_lshlrev_b32 v48, 16, v11
    v_lshlrev_b32 v49, 16, v19
    v_and_b32 v50, s30, v11
    v_and_b32 v51, s30, v19
    v_add_f32 v48, v48, v49
    v_add_f32 v50, v50, v51
    v_cvt_pk_bf16_f32 v11, v48, v50
    buffer_store_dwordx4 v[4:7], v1, s[32:35], s3 offen sc1
    buffer_store_dwordx4 v[8:11], v1, s[32:35], s3 offen offset:1024 sc1
il_ln_final_kernel_end_1:
    s_endpgm
.globl il_g1_kernel
.p2align 8
.type il_g1_kernel,@function
il_g1_kernel:
    s_cmp_ge_u32 s2, 256
    s_cbranch_scc1 il_g1_kernel_end_1
    s_load_dwordx2 s[38:39], s[0:1], 88
    s_load_dwordx2 s[24:25], s[0:1], 24
    s_load_dwordx2 s[26:27], s[0:1], 32
    s_and_b32 s23, s2, 7
    s_lshr_b32 s3, s2, 3
    s_mul_i32 s16, s23, 32
    s_add_u32 s16, s16, s3
    s_and_b32 s23, s16, 31
    s_lshr_b32 s3, s16, 5
    s_lshr_b32 s19, s3, 2
    s_and_b32 s3, s3, 3
    s_lshr_b32 s17, s3, 1
    s_and_b32 s18, s3, 1
    s_lshl_b32 s17, s17, 2
    s_lshl_b32 s18, s18, 3
    s_lshr_b32 s3, s23, 3
    s_add_u32 s17, s17, s3
    s_and_b32 s3, s23, 7
    s_add_u32 s18, s18, s3
    v_lshrrev_b32 v1, 6, v0
    v_and_b32 v2, 63, v0
    s_nop 0
    v_readfirstlane_b32 s20, v1
    s_nop 3
    s_lshr_b32 s21, s20, 1
    s_and_b32 s22, s20, 1
    s_waitcnt lgkmcnt(0)
    s_cmp_eq_u32 s19, 0
    s_cselect_b32 s24, s24, s26
    s_cselect_b32 s25, s25, s27
    s_mul_i32 s23, s17, 128
    s_mul_i32 s3, s20, 32
    s_add_u32 s23, s23, s3
    s_mul_i32 s23, s23, 2048
    s_add_u32 s4, s24, s23
    s_addc_u32 s5, s25, 0
    s_sub_u32 s6, 0x200000, s23
    s_and_b32 s5, s5, 0xffff
    s_mov_b32 s7, 0x20000
    s_mul_i32 s23, s18, 128
    s_mul_i32 s3, s20, 32
    s_add_u32 s23, s23, s3
    s_mul_i32 s23, s23, 2048
    s_add_u32 s8, s38, s23
    s_addc_u32 s9, s39, 0
    s_add_u32 s8, s8, 0x400000
    s_addc_u32 s9, s9, 0
    s_sub_u32 s10, 0x400000, s23
    s_and_b32 s9, s9, 0xffff
    s_mov_b32 s11, 0x20000
    s_cmp_eq_u32 s19, 0
    s_mov_b32 s23, 0x800000
    s_mov_b32 s3, 0xc00000
    s_cselect_b32 s23, s23, s3
    s_add_u32 s60, s38, s23
    s_addc_u32 s61, s39, 0
    s_mul_i32 s23, s17, 524288
    s_mul_i32 s3, s18, 256
    s_add_u32 s23, s23, s3
    s_add_u32 s12, s60, s23
    s_addc_u32 s13, s61, 0
    s_sub_u32 s14, 0x400000, s23
    s_and_b32 s13, s13, 0xffff
    s_mov_b32 s15, 0x20000
    v_lshrrev_b32 v3, 3, v2
    v_and_b32 v4, 7, v2
    v_lshrrev_b32 v5, 4, v2
    v_mul_u32_u24 v6, 0x800, v3
    v_xor_b32 v7, v5, v4
    v_lshl_add_u32 v16, v7, 4, v6
    v_or_b32 v7, 4, v5
    v_xor_b32 v7, v7, v4
    v_lshl_add_u32 v17, v7, 4, v6
    v_add_u32 v17, 0x3c00, v17
    v_xor_b32 v7, v5, v4
    v_lshl_add_u32 v18, v7, 4, v6
    v_add_u32 v18, 0x7800, v18
    v_or_b32 v7, 4, v5
    v_xor_b32 v7, v7, v4
    v_lshl_add_u32 v19, v7, 4, v6
    v_add_u32 v19, 0xb400, v19
    v_mul_u32_u24 v6, 0x800, v3
    v_xor_b32 v7, v5, v4
    v_lshl_add_u32 v20, v7, 4, v6
    v_or_b32 v7, 4, v5
    v_xor_b32 v7, v7, v4
    v_lshl_add_u32 v21, v7, 4, v6
    v_add_u32 v21, 0x3c00, v21
    v_xor_b32 v7, v5, v4
    v_lshl_add_u32 v22, v7, 4, v6
    v_add_u32 v22, 0x7800, v22
    v_or_b32 v7, 4, v5
    v_xor_b32 v7, v7, v4
    v_lshl_add_u32 v23, v7, 4, v6
    v_add_u32 v23, 0xb400, v23
    v_and_b32 v8, 31, v2
    v_lshrrev_b32 v9, 5, v2
    v_lshrrev_b32 v10, 1, v8
    v_and_b32 v10, 7, v10
    v_xor_b32 v10, v10, v9
    v_lshlrev_b32 v10, 4, v10
    v_lshl_add_u32 v10, v8, 7, v10
    s_mul_i32 s23, s21, 8192
    v_xor_b32 v24, 0x0, v10
    v_add_u32 v24, s23, v24
    v_xor_b32 v25, 0x20, v10
    v_add_u32 v25, s23, v25
    v_xor_b32 v26, 0x40, v10
    v_add_u32 v26, s23, v26
    v_xor_b32 v27, 0x60, v10
    v_add_u32 v27, s23, v27
    s_mul_i32 s23, s22, 8192
    s_add_u32 s23, s23, 0x10000
    v_xor_b32 v28, 0x0, v10
    v_add_u32 v28, s23, v28
    v_xor_b32 v29, 0x20, v10
    v_add_u32 v29, s23, v29
    v_xor_b32 v30, 0x40, v10
    v_add_u32 v30, s23, v30
    v_xor_b32 v31, 0x60, v10
    v_add_u32 v31, s23, v31
    s_mul_i32 s23, s20, 4096
    s_add_u32 s40, s23, 0x0
    s_mul_i32 s23, s20, 4096
    s_add_u32 s48, s23, 0x10000
    s_mul_i32 s23, s20, 4096
    s_add_u32 s41, s23, 0x4000
    s_mul_i32 s23, s20, 4096
    s_add_u32 s49, s23, 0x14000
    s_mul_i32 s23, s20, 4096
    s_add_u32 s42, s23, 0x8000
    s_mul_i32 s23, s20, 4096
    s_add_u32 s50, s23, 0x18000
    s_mul_i32 s23, s20, 4096
    s_add_u32 s43, s23, 0xc000
    s_mul_i32 s23, s20, 4096
    s_add_u32 s51, s23, 0x1c000
    s_mov_b32 s34, 0
    s_mov_b32 s35, 0
    s_mov_b32 m0, s40
    s_nop 0
    buffer_load_dwordx4 v16, s[4:7], s34 offen offset:0 lds
    buffer_load_dwordx4 v17, s[4:7], s34 offen offset:1024 lds
    buffer_load_dwordx4 v18, s[4:7], s34 offen offset:2048 lds
    buffer_load_dwordx4 v19, s[4:7], s34 offen offset:3072 lds
    s_mov_b32 m0, s48
    s_nop 0
    buffer_load_dwordx4 v20, s[8:11], s35 offen offset:0 lds
    buffer_load_dwordx4 v21, s[8:11], s35 offen offset:1024 lds
    buffer_load_dwordx4 v22, s[8:11], s35 offen offset:2048 lds
    buffer_load_dwordx4 v23, s[8:11], s35 offen offset:3072 lds
    s_add_u32 s34, s34, 128
    s_add_u32 s35, s35, 0x80
    s_mov_b32 m0, s41
    s_nop 0
    buffer_load_dwordx4 v16, s[4:7], s34 offen offset:0 lds
    buffer_load_dwordx4 v17, s[4:7], s34 offen offset:1024 lds
    buffer_load_dwordx4 v18, s[4:7], s34 offen offset:2048 lds
    buffer_load_dwordx4 v19, s[4:7], s34 offen offset:3072 lds
    s_mov_b32 m0, s49
    s_nop 0
    buffer_load_dwordx4 v20, s[8:11], s35 offen offset:0 lds
    buffer_load_dwordx4 v21, s[8:11], s35 offen offset:1024 lds
    buffer_load_dwordx4 v22, s[8:11], s35 offen offset:2048 lds
    buffer_load_dwordx4 v23, s[8:11], s35 offen offset:3072 lds
    s_add_u32 s34, s34, 128
    s_add_u32 s35, s35, 0x80
    s_mov_b32 m0, s42
    s_nop 0
    buffer_load_dwordx4 v16, s[4:7], s34 offen offset:0 lds
    buffer_load_dwordx4 v17, s[4:7], s34 offen offset:1024 lds
    buffer_load_dwordx4 v18, s[4:7], s34 offen offset:2048 lds
    buffer_load_dwordx4 v19, s[4:7], s34 offen offset:3072 lds
    s_mov_b32 m0, s50
    s_nop 0
    buffer_load_dwordx4 v20, s[8:11], s35 offen offset:0 lds
    buffer_load_dwordx4 v21, s[8:11], s35 offen offset:1024 lds
    buffer_load_dwordx4 v22, s[8:11], s35 offen offset:2048 lds
    buffer_load_dwordx4 v23, s[8:11], s35 offen offset:3072 lds
    s_add_u32 s34, s34, 128
    s_add_u32 s35, s35, 0x80
    v_mov_b32 v96, 0
    v_mov_b32 v97, 0
    v_mov_b32 v98, 0
    v_mov_b32 v99, 0
    v_mov_b32 v100, 0
    v_mov_b32 v101, 0
    v_mov_b32 v102, 0
    v_mov_b32 v103, 0
    v_mov_b32 v104, 0
    v_mov_b32 v105, 0
    v_mov_b32 v106, 0
    v_mov_b32 v107, 0
    v_mov_b32 v108, 0
    v_mov_b32 v109, 0
    v_mov_b32 v110, 0
    v_mov_b32 v111, 0
    v_mov_b32 v112, 0
    v_mov_b32 v113, 0
    v_mov_b32 v114, 0
    v_mov_b32 v115, 0
    v_mov_b32 v116, 0
    v_mov_b32 v117, 0
    v_mov_b32 v118, 0
    v_mov_b32 v119, 0
    v_mov_b32 v120, 0
    v_mov_b32 v121, 0
    v_mov_b32 v122, 0
    v_mov_b32 v123, 0
    v_mov_b32 v124, 0
    v_mov_b32 v125, 0
    v_mov_b32 v126, 0
    v_mov_b32 v127, 0
    v_mov_b32 v128, 0
    v_mov_b32 v129, 0
    v_mov_b32 v130, 0
    v_mov_b32 v131, 0
    v_mov_b32 v132, 0
    v_mov_b32 v133, 0
    v_mov_b32 v134, 0
    v_mov_b32 v135, 0
    v_mov_b32 v136, 0
    v_mov_b32 v137, 0
    v_mov_b32 v138, 0
    v_mov_b32 v139, 0
    v_mov_b32 v140, 0
    v_mov_b32 v141, 0
    v_mov_b32 v142, 0
    v_mov_b32 v143, 0
    v_mov_b32 v144, 0
    v_mov_b32 v145, 0
    v_mov_b32 v146, 0
    v_mov_b32 v147, 0
    v_mov_b32 v148, 0
    v_mov_b32 v149, 0
    v_mov_b32 v150, 0
    v_mov_b32 v151, 0
    v_mov_b32 v152, 0
    v_mov_b32 v153, 0
    v_mov_b32 v154, 0
    v_mov_b32 v155, 0
    v_mov_b32 v156, 0
    v_mov_b32 v157, 0
    v_mov_b32 v158, 0
    v_mov_b32 v159, 0
    s_waitcnt vmcnt(16)
    s_barrier
    ds_read_b128 v[32:35], v24 offset:0
    ds_read_b128 v[36:39], v24 offset:4096
    ds_read_b128 v[40:43], v28 offset:0
    ds_read_b128 v[44:47], v28 offset:4096
    ds_read_b128 v[48:51], v25 offset:0
    ds_read_b128 v[52:55], v25 offset:4096
    ds_read_b128 v[56:59], v29 offset:0
    ds_read_b128 v[60:63], v29 offset:4096
    s_mov_b32 s36, 3
il_g1_kernel_loop_2:
    s_waitcnt lgkmcnt(4)
    v_mfma_f32_32x32x16_bf16 v[96:111], v[40:43], v[32:35], v[96:111]
    ds_read_b128 v[64:67], v26 offset:0
    s_mov_b32 m0, s43
    s_nop 0
    buffer_load_dwordx4 v16, s[4:7], s34 offen offset:0 lds
    v_mfma_f32_32x32x16_bf16 v[112:127], v[44:47], v[32:35], v[112:127]
    ds_read_b128 v[68:71], v26 offset:4096
    v_mfma_f32_32x32x16_bf16 v[128:143], v[40:43], v[36:39], v[128:143]
    ds_read_b128 v[72:75], v30 offset:0
    buffer_load_dwordx4 v17, s[4:7], s34 offen offset:1024 lds
    v_mfma_f32_32x32x16_bf16 v[144:159], v[44:47], v[36:39], v[144:159]
    ds_read_b128 v[76:79], v30 offset:4096
    s_waitcnt lgkmcnt(4)
    v_mfma_f32_32x32x16_bf16 v[96:111], v[56:59], v[48:51], v[96:111]
    ds_read_b128 v[80:83], v27 offset:0
    buffer_load_dwordx4 v18, s[4:7], s34 offen offset:2048 lds
    v_mfma_f32_32x32x16_bf16 v[112:127], v[60:63], v[48:51], v[112:127]
    ds_read_b128 v[84:87], v27 offset:4096
    v_mfma_f32_32x32x16_bf16 v[128:143], v[56:59], v[52:55], v[128:143]
    ds_read_b128 v[88:91], v31 offset:0
    buffer_load_dwordx4 v19, s[4:7], s34 offen offset:3072 lds
    v_mfma_f32_32x32x16_bf16 v[144:159], v[60:63], v[52:55], v[144:159]
    ds_read_b128 v[92:95], v31 offset:4096
    s_waitcnt lgkmcnt(4)
    v_mfma_f32_32x32x16_bf16 v[96:111], v[72:75], v[64:67], v[96:111]
    s_mov_b32 m0, s51
    s_nop 0
    buffer_load_dwordx4 v20, s[8:11], s35 offen offset:0 lds
    v_mfma_f32_32x32x16_bf16 v[112:127], v[76:79], v[64:67], v[112:127]
    buffer_load_dwordx4 v21, s[8:11], s35 offen offset:1024 lds
    v_mfma_f32_32x32x16_bf16 v[128:143], v[72:75], v[68:71], v[128:143]
    buffer_load_dwordx4 v22, s[8:11], s35 offen offset:2048 lds
    v_mfma_f32_32x32x16_bf16 v[144:159], v[76:79], v[68:71], v[144:159]
    buffer_load_dwordx4 v23, s[8:11], s35 offen offset:3072 lds
    s_add_u32 s34, s34, 128
    s_add_u32 s35, s35, 0x80
    s_waitcnt lgkmcnt(0)
    s_waitcnt vmcnt(16) lgkmcnt(0)
    s_barrier
    v_mfma_f32_32x32x16_bf16 v[96:111], v[88:91], v[80:83], v[96:111]
    ds_read_b128 v[32:35], v24 offset:16384
    ds_read_b128 v[36:39], v24 offset:20480
    v_mfma_f32_32x32x16_bf16 v[112:127], v[92:95], v[80:83], v[112:127]
    ds_read_b128 v[40:43], v28 offset:16384
    ds_read_b128 v[44:47], v28 offset:20480
    v_mfma_f32_32x32x16_bf16 v[128:143], v[88:91], v[84:87], v[128:143]
    ds_read_b128 v[48:51], v25 offset:16384
    ds_read_b128 v[52:55], v25 offset:20480
    v_mfma_f32_32x32x16_bf16 v[144:159], v[92:95], v[84:87], v[144:159]
    ds_read_b128 v[56:59], v29 offset:16384
    ds_read_b128 v[60:63], v29 offset:20480
    s_waitcnt lgkmcnt(4)
    v_mfma_f32_32x32x16_bf16 v[96:111], v[40:43], v[32:35], v[96:111]
    ds_read_b128 v[64:67], v26 offset:16384
    s_mov_b32 m0, s40
    s_nop 0
    buffer_load_dwordx4 v16, s[4:7], s34 offen offset:0 lds
    v_mfma_f32_32x32x16_bf16 v[112:127], v[44:47], v[32:35], v[112:127]
    ds_read_b128 v[68:71], v26 offset:20480
    v_mfma_f32_32x32x16_bf16 v[128:143], v[40:43], v[36:39], v[128:143]
    ds_read_b128 v[72:75], v30 offset:16384
    buffer_load_dwordx4 v17, s[4:7], s34 offen offset:1024 lds
    v_mfma_f32_32x32x16_bf16 v[144:159], v[44:47], v[36:39], v[144:159]
    ds_read_b128 v[76:79], v30 offset:20480
    s_waitcnt lgkmcnt(4)
    v_mfma_f32_32x32x16_bf16 v[96:111], v[56:59], v[48:51], v[96:111]
    ds_read_b128 v[80:83], v27 offset:16384
    buffer_load_dwordx4 v18, s[4:7], s34 offen offset:2048 lds
    v_mfma_f32_32x32x16_bf16 v[112:127], v[60:63], v[48:51], v[112:127]
    ds_read_b128 v[84:87], v27 offset:20480
    v_mfma_f32_32x32x16_bf16 v[128:143], v[56:59], v[52:55], v[128:143]
    ds_read_b128 v[88:91], v31 offset:16384
    buffer_load_dwordx4 v19, s[4:7], s34 offen offset:3072 lds
    v_mfma_f32_32x32x16_bf16 v[144:159], v[60:63], v[52:55], v[144:159]
    ds_read_b128 v[92:95], v31 offset:20480
    s_waitcnt lgkmcnt(4)
    v_mfma_f32_32x32x16_bf16 v[96:111], v[72:75], v[64:67], v[96:111]
    s_mov_b32 m0, s48
    s_nop 0
    buffer_load_dwordx4 v20, s[8:11], s35 offen offset:0 lds
    v_mfma_f32_32x32x16_bf16 v[112:127], v[76:79], v[64:67], v[112:127]
    buffer_load_dwordx4 v21, s[8:11], s35 offen offset:1024 lds
    v_mfma_f32_32x32x16_bf16 v[128:143], v[72:75], v[68:71], v[128:143]
    buffer_load_dwordx4 v22, s[8:11], s35 offen offset:2048 lds
    v_mfma_f32_32x32x16_bf16 v[144:159], v[76:79], v[68:71], v[144:159]
    buffer_load_dwordx4 v23, s[8:11], s35 offen offset:3072 lds
    s_add_u32 s34, s34, 128
    s_add_u32 s35, s35, 0x80
    s_waitcnt lgkmcnt(0)
    s_waitcnt vmcnt(16) lgkmcnt(0)
    s_barrier
    v_mfma_f32_32x32x16_bf16 v[96:111], v[88:91], v[80:83], v[96:111]
    ds_read_b128 v[32:35], v24 offset:32768
    ds_read_b128 v[36:39], v24 offset:36864
    v_mfma_f32_32x32x16_bf16 v[112:127], v[92:95], v[80:83], v[112:127]
    ds_read_b128 v[40:43], v28 offset:32768
    ds_read_b128 v[44:47], v28 offset:36864
    v_mfma_f32_32x32x16_bf16 v[128:143], v[88:91], v[84:87], v[128:143]
    ds_read_b128 v[48:51], v25 offset:32768
    ds_read_b128 v[52:55], v25 offset:36864
    v_mfma_f32_32x32x16_bf16 v[144:159], v[92:95], v[84:87], v[144:159]
    ds_read_b128 v[56:59], v29 offset:32768
    ds_read_b128 v[60:63], v29 offset:36864
    s_waitcnt lgkmcnt(4)
    v_mfma_f32_32x32x16_bf16 v[96:111], v[40:43], v[32:35], v[96:111]
    ds_read_b128 v[64:67], v26 offset:32768
    s_mov_b32 m0, s41
    s_nop 0
    buffer_load_dwordx4 v16, s[4:7], s34 offen offset:0 lds
    v_mfma_f32_32x32x16_bf16 v[112:127], v[44:47], v[32:35], v[112:127]
    ds_read_b128 v[68:71], v26 offset:36864
    v_mfma_f32_32x32x16_bf16 v[128:143], v[40:43], v[36:39], v[128:143]
    ds_read_b128 v[72:75], v30 offset:32768
    buffer_load_dwordx4 v17, s[4:7], s34 offen offset:1024 lds
    v_mfma_f32_32x32x16_bf16 v[144:159], v[44:47], v[36:39], v[144:159]
    ds_read_b128 v[76:79], v30 offset:36864
    s_waitcnt lgkmcnt(4)
    v_mfma_f32_32x32x16_bf16 v[96:111], v[56:59], v[48:51], v[96:111]
    ds_read_b128 v[80:83], v27 offset:32768
    buffer_load_dwordx4 v18, s[4:7], s34 offen offset:2048 lds
    v_mfma_f32_32x32x16_bf16 v[112:127], v[60:63], v[48:51], v[112:127]
    ds_read_b128 v[84:87], v27 offset:36864
    v_mfma_f32_32x32x16_bf16 v[128:143], v[56:59], v[52:55], v[128:143]
    ds_read_b128 v[88:91], v31 offset:32768
    buffer_load_dwordx4 v19, s[4:7], s34 offen offset:3072 lds
    v_mfma_f32_32x32x16_bf16 v[144:159], v[60:63], v[52:55], v[144:159]
    ds_read_b128 v[92:95], v31 offset:36864
    s_waitcnt lgkmcnt(4)
    v_mfma_f32_32x32x16_bf16 v[96:111], v[72:75], v[64:67], v[96:111]
    s_mov_b32 m0, s49
    s_nop 0
    buffer_load_dwordx4 v20, s[8:11], s35 offen offset:0 lds
    v_mfma_f32_32x32x16_bf16 v[112:127], v[76:79], v[64:67], v[112:127]
    buffer_load_dwordx4 v21, s[8:11], s35 offen offset:1024 lds
    v_mfma_f32_32x32x16_bf16 v[128:143], v[72:75], v[68:71], v[128:143]
    buffer_load_dwordx4 v22, s[8:11], s35 offen offset:2048 lds
    v_mfma_f32_32x32x16_bf16 v[144:159], v[76:79], v[68:71], v[144:159]
    buffer_load_dwordx4 v23, s[8:11], s35 offen offset:3072 lds
    s_add_u32 s34, s34, 128
    s_add_u32 s35, s35, 0x80
    s_waitcnt lgkmcnt(0)
    s_waitcnt vmcnt(16) lgkmcnt(0)
    s_barrier
    v_mfma_f32_32x32x16_bf16 v[96:111], v[88:91], v[80:83], v[96:111]
    ds_read_b128 v[32:35], v24 offset:49152
    ds_read_b128 v[36:39], v24 offset:53248
    v_mfma_f32_32x32x16_bf16 v[112:127], v[92:95], v[80:83], v[112:127]
    ds_read_b128 v[40:43], v28 offset:49152
    ds_read_b128 v[44:47], v28 offset:53248
    v_mfma_f32_32x32x16_bf16 v[128:143], v[88:91], v[84:87], v[128:143]
    ds_read_b128 v[48:51], v25 offset:49152
    ds_read_b128 v[52:55], v25 offset:53248
    v_mfma_f32_32x32x16_bf16 v[144:159], v[92:95], v[84:87], v[144:159]
    ds_read_b128 v[56:59], v29 offset:49152
    ds_read_b128 v[60:63], v29 offset:53248
    s_waitcnt lgkmcnt(4)
    v_mfma_f32_32x32x16_bf16 v[96:111], v[40:43], v[32:35], v[96:111]
    ds_read_b128 v[64:67], v26 offset:49152
    s_mov_b32 m0, s42
    s_nop 0
    buffer_load_dwordx4 v16, s[4:7], s34 offen offset:0 lds
    v_mfma_f32_32x32x16_bf16 v[112:127], v[44:47], v[32:35], v[112:127]
    ds_read_b128 v[68:71], v26 offset:53248
    v_mfma_f32_32x32x16_bf16 v[128:143], v[40:43], v[36:39], v[128:143]
    ds_read_b128 v[72:75], v30 offset:49152
    buffer_load_dwordx4 v17, s[4:7], s34 offen offset:1024 lds
    v_mfma_f32_32x32x16_bf16 v[144:159], v[44:47], v[36:39], v[144:159]
    ds_read_b128 v[76:79], v30 offset:53248
    s_waitcnt lgkmcnt(4)
    v_mfma_f32_32x32x16_bf16 v[96:111], v[56:59], v[48:51], v[96:111]
    ds_read_b128 v[80:83], v27 offset:49152
    buffer_load_dwordx4 v18, s[4:7], s34 offen offset:2048 lds
    v_mfma_f32_32x32x16_bf16 v[112:127], v[60:63], v[48:51], v[112:127]
    ds_read_b128 v[84:87], v27 offset:53248
    v_mfma_f32_32x32x16_bf16 v[128:143], v[56:59], v[52:55], v[128:143]
    ds_read_b128 v[88:91], v31 offset:49152
    buffer_load_dwordx4 v19, s[4:7], s34 offen offset:3072 lds
    v_mfma_f32_32x32x16_bf16 v[144:159], v[60:63], v[52:55], v[144:159]
    ds_read_b128 v[92:95], v31 offset:53248
    s_waitcnt lgkmcnt(4)
    v_mfma_f32_32x32x16_bf16 v[96:111], v[72:75], v[64:67], v[96:111]
    s_mov_b32 m0, s50
    s_nop 0
    buffer_load_dwordx4 v20, s[8:11], s35 offen offset:0 lds
    v_mfma_f32_32x32x16_bf16 v[112:127], v[76:79], v[64:67], v[112:127]
    buffer_load_dwordx4 v21, s[8:11], s35 offen offset:1024 lds
    v_mfma_f32_32x32x16_bf16 v[128:143], v[72:75], v[68:71], v[128:143]
    buffer_load_dwordx4 v22, s[8:11], s35 offen offset:2048 lds
    v_mfma_f32_32x32x16_bf16 v[144:159], v[76:79], v[68:71], v[144:159]
    buffer_load_dwordx4 v23, s[8:11], s35 offen offset:3072 lds
    s_add_u32 s34, s34, 128
    s_add_u32 s35, s35, 0x80
    s_waitcnt lgkmcnt(0)
    s_waitcnt vmcnt(16) lgkmcnt(0)
    s_barrier
    v_mfma_f32_32x32x16_bf16 v[96:111], v[88:91], v[80:83], v[96:111]
    ds_read_b128 v[32:35], v24 offset:0
    ds_read_b128 v[36:39], v24 offset:4096
    v_mfma_f32_32x32x16_bf16 v[112:127], v[92:95], v[80:83], v[112:127]
    ds_read_b128 v[40:43], v28 offset:0
    ds_read_b128 v[44:47], v28 offset:4096
    v_mfma_f32_32x32x16_bf16 v[128:143], v[88:91], v[84:87], v[128:143]
    ds_read_b128 v[48:51], v25 offset:0
    ds_read_b128 v[52:55], v25 offset:4096
    v_mfma_f32_32x32x16_bf16 v[144:159], v[92:95], v[84:87], v[144:159]
    ds_read_b128 v[56:59], v29 offset:0
    ds_read_b128 v[60:63], v29 offset:4096
    s_sub_u32 s36, s36, 1
    s_cmp_lg_u32 s36, 0
    s_cbranch_scc1 il_g1_kernel_loop_2
    s_waitcnt lgkmcnt(4)
    v_mfma_f32_32x32x16_bf16 v[96:111], v[40:43], v[32:35], v[96:111]
    ds_read_b128 v[64:67], v26 offset:0
    s_mov_b32 m0, s43
    s_nop 0
    buffer_load_dwordx4 v16, s[4:7], s34 offen offset:0 lds
    v_mfma_f32_32x32x16_bf16 v[112:127], v[44:47], v[32:35], v[112:127]
    ds_read_b128 v[68:71], v26 offset:4096
    v_mfma_f32_32x32x16_bf16 v[128:143], v[40:43], v[36:39], v[128:143]
    ds_read_b128 v[72:75], v30 offset:0
    buffer_load_dwordx4 v17, s[4:7], s34 offen offset:1024 lds
    v_mfma_f32_32x32x16_bf16 v[144:159], v[44:47], v[36:39], v[144:159]
    ds_read_b128 v[76:79], v30 offset:4096
    s_waitcnt lgkmcnt(4)
    v_mfma_f32_32x32x16_bf16 v[96:111], v[56:59], v[48:51], v[96:111]
    ds_read_b128 v[80:83], v27 offset:0
    buffer_load_dwordx4 v18, s[4:7], s34 offen offset:2048 lds
    v_mfma_f32_32x32x16_bf16 v[112:127], v[60:63], v[48:51], v[112:127]
    ds_read_b128 v[84:87], v27 offset:4096
    v_mfma_f32_32x32x16_bf16 v[128:143], v[56:59], v[52:55], v[128:143]
    ds_read_b128 v[88:91], v31 offset:0
    buffer_load_dwordx4 v19, s[4:7], s34 offen offset:3072 lds
    v_mfma_f32_32x32x16_bf16 v[144:159], v[60:63], v[52:55], v[144:159]
    ds_read_b128 v[92:95], v31 offset:4096
    s_waitcnt lgkmcnt(4)
    v_mfma_f32_32x32x16_bf16 v[96:111], v[72:75], v[64:67], v[96:111]
    s_mov_b32 m0, s51
    s_nop 0
    buffer_load_dwordx4 v20, s[8:11], s35 offen offset:0 lds
    v_mfma_f32_32x32x16_bf16 v[112:127], v[76:79], v[64:67], v[112:127]
    buffer_load_dwordx4 v21, s[8:11], s35 offen offset:1024 lds
    v_mfma_f32_32x32x16_bf16 v[128:143], v[72:75], v[68:71], v[128:143]
    buffer_load_dwordx4 v22, s[8:11], s35 offen offset:2048 lds
    v_mfma_f32_32x32x16_bf16 v[144:159], v[76:79], v[68:71], v[144:159]
    buffer_load_dwordx4 v23, s[8:11], s35 offen offset:3072 lds
    s_add_u32 s34, s34, 128
    s_add_u32 s35, s35, 0x80
    s_waitcnt lgkmcnt(0)
    s_waitcnt vmcnt(16) lgkmcnt(0)
    s_barrier
    v_mfma_f32_32x32x16_bf16 v[96:111], v[88:91], v[80:83], v[96:111]
    ds_read_b128 v[32:35], v24 offset:16384
    ds_read_b128 v[36:39], v24 offset:20480
    v_mfma_f32_32x32x16_bf16 v[112:127], v[92:95], v[80:83], v[112:127]
    ds_read_b128 v[40:43], v28 offset:16384
    ds_read_b128 v[44:47], v28 offset:20480
    v_mfma_f32_32x32x16_bf16 v[128:143], v[88:91], v[84:87], v[128:143]
    ds_read_b128 v[48:51], v25 offset:16384
    ds_read_b128 v[52:55], v25 offset:20480
    v_mfma_f32_32x32x16_bf16 v[144:159], v[92:95], v[84:87], v[144:159]
    ds_read_b128 v[56:59], v29 offset:16384
    ds_read_b128 v[60:63], v29 offset:20480
    s_waitcnt lgkmcnt(4)
    v_mfma_f32_32x32x16_bf16 v[96:111], v[40:43], v[32:35], v[96:111]
    ds_read_b128 v[64:67], v26 offset:16384
    v_mfma_f32_32x32x16_bf16 v[112:127], v[44:47], v[32:35], v[112:127]
    ds_read_b128 v[68:71], v26 offset:20480
    v_mfma_f32_32x32x16_bf16 v[128:143], v[40:43], v[36:39], v[128:143]
    ds_read_b128 v[72:75], v30 offset:16384
    v_mfma_f32_32x32x16_bf16 v[144:159], v[44:47], v[36:39], v[144:159]
    ds_read_b128 v[76:79], v30 offset:20480
    s_waitcnt lgkmcnt(4)
    v_mfma_f32_32x32x16_bf16 v[96:111], v[56:59], v[48:51], v[96:111]
    ds_read_b128 v[80:83], v27 offset:16384
    v_mfma_f32_32x32x16_bf16 v[112:127], v[60:63], v[48:51], v[112:127]
    ds_read_b128 v[84:87], v27 offset:20480
    v_mfma_f32_32x32x16_bf16 v[128:143], v[56:59], v[52:55], v[128:143]
    ds_read_b128 v[88:91], v31 offset:16384
    v_mfma_f32_32x32x16_bf16 v[144:159], v[60:63], v[52:55], v[144:159]
    ds_read_b128 v[92:95], v31 offset:20480
    s_waitcnt lgkmcnt(4)
    v_mfma_f32_32x32x16_bf16 v[96:111], v[72:75], v[64:67], v[96:111]
    v_mfma_f32_32x32x16_bf16 v[112:127], v[76:79], v[64:67], v[112:127]
    v_mfma_f32_32x32x16_bf16 v[128:143], v[72:75], v[68:71], v[128:143]
    v_mfma_f32_32x32x16_bf16 v[144:159], v[76:79], v[68:71], v[144:159]
    s_waitcnt lgkmcnt(0)
    s_waitcnt vmcnt(8) lgkmcnt(0)
    s_barrier
    v_mfma_f32_32x32x16_bf16 v[96:111], v[88:91], v[80:83], v[96:111]
    ds_read_b128 v[32:35], v24 offset:32768
    ds_read_b128 v[36:39], v24 offset:36864
    v_mfma_f32_32x32x16_bf16 v[112:127], v[92:95], v[80:83], v[112:127]
    ds_read_b128 v[40:43], v28 offset:32768
    ds_read_b128 v[44:47], v28 offset:36864
    v_mfma_f32_32x32x16_bf16 v[128:143], v[88:91], v[84:87], v[128:143]
    ds_read_b128 v[48:51], v25 offset:32768
    ds_read_b128 v[52:55], v25 offset:36864
    v_mfma_f32_32x32x16_bf16 v[144:159], v[92:95], v[84:87], v[144:159]
    ds_read_b128 v[56:59], v29 offset:32768
    ds_read_b128 v[60:63], v29 offset:36864
    s_waitcnt lgkmcnt(4)
    v_mfma_f32_32x32x16_bf16 v[96:111], v[40:43], v[32:35], v[96:111]
    ds_read_b128 v[64:67], v26 offset:32768
    v_mfma_f32_32x32x16_bf16 v[112:127], v[44:47], v[32:35], v[112:127]
    ds_read_b128 v[68:71], v26 offset:36864
    v_mfma_f32_32x32x16_bf16 v[128:143], v[40:43], v[36:39], v[128:143]
    ds_read_b128 v[72:75], v30 offset:32768
    v_mfma_f32_32x32x16_bf16 v[144:159], v[44:47], v[36:39], v[144:159]
    ds_read_b128 v[76:79], v30 offset:36864
    s_waitcnt lgkmcnt(4)
    v_mfma_f32_32x32x16_bf16 v[96:111], v[56:59], v[48:51], v[96:111]
    ds_read_b128 v[80:83], v27 offset:32768
    v_mfma_f32_32x32x16_bf16 v[112:127], v[60:63], v[48:51], v[112:127]
    ds_read_b128 v[84:87], v27 offset:36864
    v_mfma_f32_32x32x16_bf16 v[128:143], v[56:59], v[52:55], v[128:143]
    ds_read_b128 v[88:91], v31 offset:32768
    v_mfma_f32_32x32x16_bf16 v[144:159], v[60:63], v[52:55], v[144:159]
    ds_read_b128 v[92:95], v31 offset:36864
    s_waitcnt lgkmcnt(4)
    v_mfma_f32_32x32x16_bf16 v[96:111], v[72:75], v[64:67], v[96:111]
    v_mfma_f32_32x32x16_bf16 v[112:127], v[76:79], v[64:67], v[112:127]
    v_mfma_f32_32x32x16_bf16 v[128:143], v[72:75], v[68:71], v[128:143]
    v_mfma_f32_32x32x16_bf16 v[144:159], v[76:79], v[68:71], v[144:159]
    s_waitcnt lgkmcnt(0)
    s_waitcnt vmcnt(0) lgkmcnt(0)
    s_barrier
    v_mfma_f32_32x32x16_bf16 v[96:111], v[88:91], v[80:83], v[96:111]
    ds_read_b128 v[32:35], v24 offset:49152
    ds_read_b128 v[36:39], v24 offset:53248
    v_mfma_f32_32x32x16_bf16 v[112:127], v[92:95], v[80:83], v[112:127]
    ds_read_b128 v[40:43], v28 offset:49152
    ds_read_b128 v[44:47], v28 offset:53248
    v_mfma_f32_32x32x16_bf16 v[128:143], v[88:91], v[84:87], v[128:143]
    ds_read_b128 v[48:51], v25 offset:49152
    ds_read_b128 v[52:55], v25 offset:53248
    v_mfma_f32_32x32x16_bf16 v[144:159], v[92:95], v[84:87], v[144:159]
    ds_read_b128 v[56:59], v29 offset:49152
    ds_read_b128 v[60:63], v29 offset:53248
    s_waitcnt lgkmcnt(4)
    v_mfma_f32_32x32x16_bf16 v[96:111], v[40:43], v[32:35], v[96:111]
    ds_read_b128 v[64:67], v26 offset:49152
    v_mfma_f32_32x32x16_bf16 v[112:127], v[44:47], v[32:35], v[112:127]
    ds_read_b128 v[68:71], v26 offset:53248
    v_mfma_f32_32x32x16_bf16 v[128:143], v[40:43], v[36:39], v[128:143]
    ds_read_b128 v[72:75], v30 offset:49152
    v_mfma_f32_32x32x16_bf16 v[144:159], v[44:47], v[36:39], v[144:159]
    ds_read_b128 v[76:79], v30 offset:53248
    s_waitcnt lgkmcnt(4)
    v_mfma_f32_32x32x16_bf16 v[96:111], v[56:59], v[48:51], v[96:111]
    ds_read_b128 v[80:83], v27 offset:49152
    v_mfma_f32_32x32x16_bf16 v[112:127], v[60:63], v[48:51], v[112:127]
    ds_read_b128 v[84:87], v27 offset:53248
    v_mfma_f32_32x32x16_bf16 v[128:143], v[56:59], v[52:55], v[128:143]
    ds_read_b128 v[88:91], v31 offset:49152
    v_mfma_f32_32x32x16_bf16 v[144:159], v[60:63], v[52:55], v[144:159]
    ds_read_b128 v[92:95], v31 offset:53248
    s_waitcnt lgkmcnt(4)
    v_mfma_f32_32x32x16_bf16 v[96:111], v[72:75], v[64:67], v[96:111]
    v_mfma_f32_32x32x16_bf16 v[112:127], v[76:79], v[64:67], v[112:127]
    v_mfma_f32_32x32x16_bf16 v[128:143], v[72:75], v[68:71], v[128:143]
    v_mfma_f32_32x32x16_bf16 v[144:159], v[76:79], v[68:71], v[144:159]
    s_waitcnt lgkmcnt(0)
    v_mfma_f32_32x32x16_bf16 v[96:111], v[88:91], v[80:83], v[96:111]
    v_mfma_f32_32x32x16_bf16 v[112:127], v[92:95], v[80:83], v[112:127]
    v_mfma_f32_32x32x16_bf16 v[128:143], v[88:91], v[84:87], v[128:143]
    v_mfma_f32_32x32x16_bf16 v[144:159], v[92:95], v[84:87], v[144:159]
    s_nop 15
    s_nop 3
    s_barrier
    s_mul_i32 s23, s20, 8192
    v_and_b32 v10, 7, v8
    v_lshlrev_b32 v10, 4, v10
    v_lshl_add_u32 v10, v9, 3, v10
    v_mul_u32_u24 v13, 128, v8
    v_add_u32 v10, v10, v13
    v_add_u32 v10, s23, v10
    v_lshrrev_b32 v13, 3, v2
    v_and_b32 v14, 7, v2
    v_and_b32 v15, 7, v13
    v_xor_b32 v15, v15, v14
    v_lshlrev_b32 v15, 4, v15
    v_mul_u32_u24 v11, 128, v13
    v_add_u32 v11, v11, v15
    v_add_u32 v11, s23, v11
    s_mul_i32 s23, s21, 64
    v_add_u32 v13, s23, v13
    v_mul_u32_u24 v12, 0x1000, v13
    v_lshl_add_u32 v12, v14, 4, v12
    s_mul_i32 s23, s22, 128
    v_add_u32 v12, s23, v12
    v_cvt_pk_bf16_f32 v96, v96, v97
    v_cvt_pk_bf16_f32 v97, v98, v99
    ds_write_b64 v10, v[96:97] offset:0
    v_cvt_pk_bf16_f32 v100, v100, v101
    v_cvt_pk_bf16_f32 v101, v102, v103
    v_xor_b32 v13, 0x10, v10
    ds_write_b64 v13, v[100:101] offset:0
    v_cvt_pk_bf16_f32 v104, v104, v105
    v_cvt_pk_bf16_f32 v105, v106, v107
    v_xor_b32 v13, 0x20, v10
    ds_write_b64 v13, v[104:105] offset:0
    v_cvt_pk_bf16_f32 v108, v108, v109
    v_cvt_pk_bf16_f32 v109, v110, v111
    v_xor_b32 v13, 0x30, v10
    ds_write_b64 v13, v[108:109] offset:0
    v_cvt_pk_bf16_f32 v112, v112, v113
    v_cvt_pk_bf16_f32 v113, v114, v115
    v_xor_b32 v13, 0x40, v10
    ds_write_b64 v13, v[112:113] offset:0
    v_cvt_pk_bf16_f32 v116, v116, v117
    v_cvt_pk_bf16_f32 v117, v118, v119
    v_xor_b32 v13, 0x50, v10
    ds_write_b64 v13, v[116:117] offset:0
    v_cvt_pk_bf16_f32 v120, v120, v121
    v_cvt_pk_bf16_f32 v121, v122, v123
    v_xor_b32 v13, 0x60, v10
    ds_write_b64 v13, v[120:121] offset:0
    v_cvt_pk_bf16_f32 v124, v124, v125
    v_cvt_pk_bf16_f32 v125, v126, v127
    v_xor_b32 v13, 0x70, v10
    ds_write_b64 v13, v[124:125] offset:0
    v_cvt_pk_bf16_f32 v128, v128, v129
    v_cvt_pk_bf16_f32 v129, v130, v131
    ds_write_b64 v10, v[128:129] offset:4096
    v_cvt_pk_bf16_f32 v132, v132, v133
    v_cvt_pk_bf16_f32 v133, v134, v135
    v_xor_b32 v13, 0x10, v10
    ds_write_b64 v13, v[132:133] offset:4096
    v_cvt_pk_bf16_f32 v136, v136, v137
    v_cvt_pk_bf16_f32 v137, v138, v139
    v_xor_b32 v13, 0x20, v10
    ds_write_b64 v13, v[136:137] offset:4096
    v_cvt_pk_bf16_f32 v140, v140, v141
    v_cvt_pk_bf16_f32 v141, v142, v143
    v_xor_b32 v13, 0x30, v10
    ds_write_b64 v13, v[140:141] offset:4096
    v_cvt_pk_bf16_f32 v144, v144, v145
    v_cvt_pk_bf16_f32 v145, v146, v147
    v_xor_b32 v13, 0x40, v10
    ds_write_b64 v13, v[144:145] offset:4096
    v_cvt_pk_bf16_f32 v148, v148, v149
    v_cvt_pk_bf16_f32 v149, v150, v151
    v_xor_b32 v13, 0x50, v10
    ds_write_b64 v13, v[148:149] offset:4096
    v_cvt_pk_bf16_f32 v152, v152, v153
    v_cvt_pk_bf16_f32 v153, v154, v155
    v_xor_b32 v13, 0x60, v10
    ds_write_b64 v13, v[152:153] offset:4096
    v_cvt_pk_bf16_f32 v156, v156, v157
    v_cvt_pk_bf16_f32 v157, v158, v159
    v_xor_b32 v13, 0x70, v10
    ds_write_b64 v13, v[156:157] offset:4096
    s_waitcnt lgkmcnt(0)
    ds_read_b128 v[96:99], v11 offset:0
    ds_read_b128 v[100:103], v11 offset:1024
    ds_read_b128 v[104:107], v11 offset:2048
    ds_read_b128 v[108:111], v11 offset:3072
    ds_read_b128 v[112:115], v11 offset:4096
    ds_read_b128 v[116:119], v11 offset:5120
    ds_read_b128 v[120:123], v11 offset:6144
    ds_read_b128 v[124:127], v11 offset:7168
    s_waitcnt lgkmcnt(7)
    buffer_store_dwordx4 v[96:99], v12, s[12:15], 0 offen sc1
    v_add_u32 v12, 0x8000, v12
    s_waitcnt lgkmcnt(6)
    buffer_store_dwordx4 v[100:103], v12, s[12:15], 0 offen sc1
    v_add_u32 v12, 0x8000, v12
    s_waitcnt lgkmcnt(5)
    buffer_store_dwordx4 v[104:107], v12, s[12:15], 0 offen sc1
    v_add_u32 v12, 0x8000, v12
    s_waitcnt lgkmcnt(4)
    buffer_store_dwordx4 v[108:111], v12, s[12:15], 0 offen sc1
    v_add_u32 v12, 0x8000, v12
    s_waitcnt lgkmcnt(3)
    buffer_store_dwordx4 v[112:115], v12, s[12:15], 0 offen sc1
    v_add_u32 v12, 0x8000, v12
    s_waitcnt lgkmcnt(2)
    buffer_store_dwordx4 v[116:119], v12, s[12:15], 0 offen sc1
    v_add_u32 v12, 0x8000, v12
    s_waitcnt lgkmcnt(1)
    buffer_store_dwordx4 v[120:123], v12, s[12:15], 0 offen sc1
    v_add_u32 v12, 0x8000, v12
    s_waitcnt lgkmcnt(0)
    buffer_store_dwordx4 v[124:127], v12, s[12:15], 0 offen sc1
il_g1_kernel_end_1:
    s_endpgm
.globl il_g2_kernel
.p2align 8
.type il_g2_kernel,@function
il_g2_kernel:
    s_cmp_ge_u32 s2, 256
    s_cbranch_scc1 il_g2_kernel_end_1
    s_load_dwordx2 s[38:39], s[0:1], 88
    s_load_dwordx2 s[24:25], s[0:1], 8
    s_load_dwordx2 s[26:27], s[0:1], 16
    s_and_b32 s23, s2, 7
    s_lshr_b32 s3, s2, 3
    s_mul_i32 s16, s23, 32
    s_add_u32 s16, s16, s3
    s_and_b32 s23, s16, 31
    s_lshr_b32 s3, s16, 5
    s_lshr_b32 s19, s3, 2
    s_and_b32 s3, s3, 3
    s_lshr_b32 s17, s3, 0
    s_and_b32 s18, s3, 0
    s_lshl_b32 s17, s17, 2
    s_lshl_b32 s18, s18, 3
    s_lshr_b32 s3, s23, 3
    s_add_u32 s17, s17, s3
    s_and_b32 s3, s23, 7
    s_add_u32 s18, s18, s3
    v_lshrrev_b32 v1, 6, v0
    v_and_b32 v2, 63, v0
    s_nop 0
    v_readfirstlane_b32 s20, v1
    s_nop 3
    s_lshr_b32 s21, s20, 1
    s_and_b32 s22, s20, 1
    s_waitcnt lgkmcnt(0)
    s_cmp_eq_u32 s19, 0
    s_cselect_b32 s24, s24, s26
    s_cselect_b32 s25, s25, s27
    s_mul_i32 s23, s17, 128
    s_mul_i32 s3, s20, 32
    s_add_u32 s23, s23, s3
    s_mul_i32 s23, s23, 4096
    s_add_u32 s4, s24, s23
    s_addc_u32 s5, s25, 0
    s_sub_u32 s6, 0x800000, s23
    s_and_b32 s5, s5, 0xffff
    s_mov_b32 s7, 0x20000
    s_cmp_eq_u32 s19, 0
    s_mov_b32 s23, 0x800000
    s_mov_b32 s3, 0xc00000
    s_cselect_b32 s23, s23, s3
    s_add_u32 s58, s38, s23
    s_addc_u32 s59, s39, 0
    s_mul_i32 s23, s18, 128
    s_mul_i32 s3, s20, 32
    s_add_u32 s23, s23, s3
    s_mul_i32 s23, s23, 4096
    s_add_u32 s8, s58, s23
    s_addc_u32 s9, s59, 0
    s_sub_u32 s10, 0x400000, s23
    s_and_b32 s9, s9, 0xffff
    s_mov_b32 s11, 0x20000
    s_cmp_eq_u32 s19, 0
    s_mov_b32 s23, 0x1000000
    s_mov_b32 s3, 0x1400000
    s_cselect_b32 s23, s23, s3
    s_add_u32 s60, s38, s23
    s_addc_u32 s61, s39, 0
    s_mul_i32 s23, s17, 262144
    s_mul_i32 s3, s18, 256
    s_add_u32 s23, s23, s3
    s_add_u32 s12, s60, s23
    s_addc_u32 s13, s61, 0
    s_sub_u32 s14, 0x400000, s23
    s_and_b32 s13, s13, 0xffff
    s_mov_b32 s15, 0x20000
    v_lshrrev_b32 v3, 3, v2
    v_and_b32 v4, 7, v2
    v_lshrrev_b32 v5, 4, v2
    v_mul_u32_u24 v6, 0x1000, v3
    v_xor_b32 v7, v5, v4
    v_lshl_add_u32 v16, v7, 4, v6
    v_or_b32 v7, 4, v5
    v_xor_b32 v7, v7, v4
    v_lshl_add_u32 v17, v7, 4, v6
    v_add_u32 v17, 0x7c00, v17
    v_xor_b32 v7, v5, v4
    v_lshl_add_u32 v18, v7, 4, v6
    v_add_u32 v18, 0xf800, v18
    v_or_b32 v7, 4, v5
    v_xor_b32 v7, v7, v4
    v_lshl_add_u32 v19, v7, 4, v6
    v_add_u32 v19, 0x17400, v19
    v_mul_u32_u24 v6, 0x1000, v3
    v_xor_b32 v7, v5, v4
    v_lshl_add_u32 v20, v7, 4, v6
    v_or_b32 v7, 4, v5
    v_xor_b32 v7, v7, v4
    v_lshl_add_u32 v21, v7, 4, v6
    v_add_u32 v21, 0x7c00, v21
    v_xor_b32 v7, v5, v4
    v_lshl_add_u32 v22, v7, 4, v6
    v_add_u32 v22, 0xf800, v22
    v_or_b32 v7, 4, v5
    v_xor_b32 v7, v7, v4
    v_lshl_add_u32 v23, v7, 4, v6
    v_add_u32 v23, 0x17400, v23
    v_and_b32 v8, 31, v2
    v_lshrrev_b32 v9, 5, v2
    v_lshrrev_b32 v10, 1, v8
    v_and_b32 v10, 7, v10
    v_xor_b32 v10, v10, v9
    v_lshlrev_b32 v10, 4, v10
    v_lshl_add_u32 v10, v8, 7, v10
    s_mul_i32 s23, s21, 8192
    v_xor_b32 v24, 0x0, v10
    v_add_u32 v24, s23, v24
    v_xor_b32 v25, 0x20, v10
    v_add_u32 v25, s23, v25
    v_xor_b32 v26, 0x40, v10
    v_add_u32 v26, s23, v26
    v_xor_b32 v27, 0x60, v10
    v_add_u32 v27, s23, v27
    s_mul_i32 s23, s22, 8192
    s_add_u32 s23, s23, 0x10000
    v_xor_b32 v28, 0x0, v10
    v_add_u32 v28, s23, v28
    v_xor_b32 v29, 0x20, v10
    v_add_u32 v29, s23, v29
    v_xor_b32 v30, 0x40, v10
    v_add_u32 v30, s23, v30
    v_xor_b32 v31, 0x60, v10
    v_add_u32 v31, s23, v31
    s_mul_i32 s23, s20, 4096
    s_add_u32 s40, s23, 0x0
    s_mul_i32 s23, s20, 4096
    s_add_u32 s48, s23, 0x10000
    s_mul_i32 s23, s20, 4096
    s_add_u32 s41, s23, 0x4000
    s_mul_i32 s23, s20, 4096
    s_add_u32 s49, s23, 0x14000
    s_mul_i32 s23, s20, 4096
    s_add_u32 s42, s23, 0x8000
    s_mul_i32 s23, s20, 4096
    s_add_u32 s50, s23, 0x18000
    s_mul_i32 s23, s20, 4096
    s_add_u32 s43, s23, 0xc000
    s_mul_i32 s23, s20, 4096
    s_add_u32 s51, s23, 0x1c000
    s_mov_b32 s34, 0
    s_mov_b32 s35, 0
    s_mov_b32 m0, s40
    s_nop 0
    buffer_load_dwordx4 v16, s[4:7], s34 offen offset:0 lds
    buffer_load_dwordx4 v17, s[4:7], s34 offen offset:1024 lds
    buffer_load_dwordx4 v18, s[4:7], s34 offen offset:2048 lds
    buffer_load_dwordx4 v19, s[4:7], s34 offen offset:3072 lds
    s_mov_b32 m0, s48
    s_nop 0
    buffer_load_dwordx4 v20, s[8:11], s35 offen offset:0 lds
    buffer_load_dwordx4 v21, s[8:11], s35 offen offset:1024 lds
    buffer_load_dwordx4 v22, s[8:11], s35 offen offset:2048 lds
    buffer_load_dwordx4 v23, s[8:11], s35 offen offset:3072 lds
    s_add_u32 s34, s34, 128
    s_add_u32 s35, s35, 0x80
    s_mov_b32 m0, s41
    s_nop 0
    buffer_load_dwordx4 v16, s[4:7], s34 offen offset:0 lds
    buffer_load_dwordx4 v17, s[4:7], s34 offen offset:1024 lds
    buffer_load_dwordx4 v18, s[4:7], s34 offen offset:2048 lds
    buffer_load_dwordx4 v19, s[4:7], s34 offen offset:3072 lds
    s_mov_b32 m0, s49
    s_nop 0
    buffer_load_dwordx4 v20, s[8:11], s35 offen offset:0 lds
    buffer_load_dwordx4 v21, s[8:11], s35 offen offset:1024 lds
    buffer_load_dwordx4 v22, s[8:11], s35 offen offset:2048 lds
    buffer_load_dwordx4 v23, s[8:11], s35 offen offset:3072 lds
    s_add_u32 s34, s34, 128
    s_add_u32 s35, s35, 0x80
    s_mov_b32 m0, s42
    s_nop 0
    buffer_load_dwordx4 v16, s[4:7], s34 offen offset:0 lds
    buffer_load_dwordx4 v17, s[4:7], s34 offen offset:1024 lds
    buffer_load_dwordx4 v18, s[4:7], s34 offen offset:2048 lds
    buffer_load_dwordx4 v19, s[4:7], s34 offen offset:3072 lds
    s_mov_b32 m0, s50
    s_nop 0
    buffer_load_dwordx4 v20, s[8:11], s35 offen offset:0 lds
    buffer_load_dwordx4 v21, s[8:11], s35 offen offset:1024 lds
    buffer_load_dwordx4 v22, s[8:11], s35 offen offset:2048 lds
    buffer_load_dwordx4 v23, s[8:11], s35 offen offset:3072 lds
    s_add_u32 s34, s34, 128
    s_add_u32 s35, s35, 0x80
    v_mov_b32 v96, 0
    v_mov_b32 v97, 0
    v_mov_b32 v98, 0
    v_mov_b32 v99, 0
    v_mov_b32 v100, 0
    v_mov_b32 v101, 0
    v_mov_b32 v102, 0
    v_mov_b32 v103, 0
    v_mov_b32 v104, 0
    v_mov_b32 v105, 0
    v_mov_b32 v106, 0
    v_mov_b32 v107, 0
    v_mov_b32 v108, 0
    v_mov_b32 v109, 0
    v_mov_b32 v110, 0
    v_mov_b32 v111, 0
    v_mov_b32 v112, 0
    v_mov_b32 v113, 0
    v_mov_b32 v114, 0
    v_mov_b32 v115, 0
    v_mov_b32 v116, 0
    v_mov_b32 v117, 0
    v_mov_b32 v118, 0
    v_mov_b32 v119, 0
    v_mov_b32 v120, 0
    v_mov_b32 v121, 0
    v_mov_b32 v122, 0
    v_mov_b32 v123, 0
    v_mov_b32 v124, 0
    v_mov_b32 v125, 0
    v_mov_b32 v126, 0
    v_mov_b32 v127, 0
    v_mov_b32 v128, 0
    v_mov_b32 v129, 0
    v_mov_b32 v130, 0
    v_mov_b32 v131, 0
    v_mov_b32 v132, 0
    v_mov_b32 v133, 0
    v_mov_b32 v134, 0
    v_mov_b32 v135, 0
    v_mov_b32 v136, 0
    v_mov_b32 v137, 0
    v_mov_b32 v138, 0
    v_mov_b32 v139, 0
    v_mov_b32 v140, 0
    v_mov_b32 v141, 0
    v_mov_b32 v142, 0
    v_mov_b32 v143, 0
    v_mov_b32 v144, 0
    v_mov_b32 v145, 0
    v_mov_b32 v146, 0
    v_mov_b32 v147, 0
    v_mov_b32 v148, 0
    v_mov_b32 v149, 0
    v_mov_b32 v150, 0
    v_mov_b32 v151, 0
    v_mov_b32 v152, 0
    v_mov_b32 v153, 0
    v_mov_b32 v154, 0
    v_mov_b32 v155, 0
    v_mov_b32 v156, 0
    v_mov_b32 v157, 0
    v_mov_b32 v158, 0
    v_mov_b32 v159, 0
    s_waitcnt vmcnt(16)
    s_barrier
    ds_read_b128 v[32:35], v24 offset:0
    ds_read_b128 v[36:39], v24 offset:4096
    ds_read_b128 v[40:43], v28 offset:0
    ds_read_b128 v[44:47], v28 offset:4096
    ds_read_b128 v[48:51], v25 offset:0
    ds_read_b128 v[52:55], v25 offset:4096
    ds_read_b128 v[56:59], v29 offset:0
    ds_read_b128 v[60:63], v29 offset:4096
    s_mov_b32 s36, 7
il_g2_kernel_loop_2:
    s_waitcnt lgkmcnt(4)
    v_mfma_f32_32x32x16_bf16 v[96:111], v[40:43], v[32:35], v[96:111]
    ds_read_b128 v[64:67], v26 offset:0
    s_mov_b32 m0, s43
    s_nop 0
    buffer_load_dwordx4 v16, s[4:7], s34 offen offset:0 lds
    v_mfma_f32_32x32x16_bf16 v[112:127], v[44:47], v[32:35], v[112:127]
    ds_read_b128 v[68:71], v26 offset:4096
    v_mfma_f32_32x32x16_bf16 v[128:143], v[40:43], v[36:39], v[128:143]
    ds_read_b128 v[72:75], v30 offset:0
    buffer_load_dwordx4 v17, s[4:7], s34 offen offset:1024 lds
    v_mfma_f32_32x32x16_bf16 v[144:159], v[44:47], v[36:39], v[144:159]
    ds_read_b128 v[76:79], v30 offset:4096
    s_waitcnt lgkmcnt(4)
    v_mfma_f32_32x32x16_bf16 v[96:111], v[56:59], v[48:51], v[96:111]
    ds_read_b128 v[80:83], v27 offset:0
    buffer_load_dwordx4 v18, s[4:7], s34 offen offset:2048 lds
    v_mfma_f32_32x32x16_bf16 v[112:127], v[60:63], v[48:51], v[112:127]
    ds_read_b128 v[84:87], v27 offset:4096
    v_mfma_f32_32x32x16_bf16 v[128:143], v[56:59], v[52:55], v[128:143]
    ds_read_b128 v[88:91], v31 offset:0
    buffer_load_dwordx4 v19, s[4:7], s34 offen offset:3072 lds
    v_mfma_f32_32x32x16_bf16 v[144:159], v[60:63], v[52:55], v[144:159]
    ds_read_b128 v[92:95], v31 offset:4096
    s_waitcnt lgkmcnt(4)
    v_mfma_f32_32x32x16_bf16 v[96:111], v[72:75], v[64:67], v[96:111]
    s_mov_b32 m0, s51
    s_nop 0
    buffer_load_dwordx4 v20, s[8:11], s35 offen offset:0 lds
    v_mfma_f32_32x32x16_bf16 v[112:127], v[76:79], v[64:67], v[112:127]
    buffer_load_dwordx4 v21, s[8:11], s35 offen offset:1024 lds
    v_mfma_f32_32x32x16_bf16 v[128:143], v[72:75], v[68:71], v[128:143]
    buffer_load_dwordx4 v22, s[8:11], s35 offen offset:2048 lds
    v_mfma_f32_32x32x16_bf16 v[144:159], v[76:79], v[68:71], v[144:159]
    buffer_load_dwordx4 v23, s[8:11], s35 offen offset:3072 lds
    s_add_u32 s34, s34, 128
    s_add_u32 s35, s35, 0x80
    s_waitcnt lgkmcnt(0)
    s_waitcnt vmcnt(16) lgkmcnt(0)
    s_barrier
    v_mfma_f32_32x32x16_bf16 v[96:111], v[88:91], v[80:83], v[96:111]
    ds_read_b128 v[32:35], v24 offset:16384
    ds_read_b128 v[36:39], v24 offset:20480
    v_mfma_f32_32x32x16_bf16 v[112:127], v[92:95], v[80:83], v[112:127]
    ds_read_b128 v[40:43], v28 offset:16384
    ds_read_b128 v[44:47], v28 offset:20480
    v_mfma_f32_32x32x16_bf16 v[128:143], v[88:91], v[84:87], v[128:143]
    ds_read_b128 v[48:51], v25 offset:16384
    ds_read_b128 v[52:55], v25 offset:20480
    v_mfma_f32_32x32x16_bf16 v[144:159], v[92:95], v[84:87], v[144:159]
    ds_read_b128 v[56:59], v29 offset:16384
    ds_read_b128 v[60:63], v29 offset:20480
    s_waitcnt lgkmcnt(4)
    v_mfma_f32_32x32x16_bf16 v[96:111], v[40:43], v[32:35], v[96:111]
    ds_read_b128 v[64:67], v26 offset:16384
    s_mov_b32 m0, s40
    s_nop 0
    buffer_load_dwordx4 v16, s[4:7], s34 offen offset:0 lds
    v_mfma_f32_32x32x16_bf16 v[112:127], v[44:47], v[32:35], v[112:127]
    ds_read_b128 v[68:71], v26 offset:20480
    v_mfma_f32_32x32x16_bf16 v[128:143], v[40:43], v[36:39], v[128:143]
    ds_read_b128 v[72:75], v30 offset:16384
    buffer_load_dwordx4 v17, s[4:7], s34 offen offset:1024 lds
    v_mfma_f32_32x32x16_bf16 v[144:159], v[44:47], v[36:39], v[144:159]
    ds_read_b128 v[76:79], v30 offset:20480
    s_waitcnt lgkmcnt(4)
    v_mfma_f32_32x32x16_bf16 v[96:111], v[56:59], v[48:51], v[96:111]
    ds_read_b128 v[80:83], v27 offset:16384
    buffer_load_dwordx4 v18, s[4:7], s34 offen offset:2048 lds
    v_mfma_f32_32x32x16_bf16 v[112:127], v[60:63], v[48:51], v[112:127]
    ds_read_b128 v[84:87], v27 offset:20480
    v_mfma_f32_32x32x16_bf16 v[128:143], v[56:59], v[52:55], v[128:143]
    ds_read_b128 v[88:91], v31 offset:16384
    buffer_load_dwordx4 v19, s[4:7], s34 offen offset:3072 lds
    v_mfma_f32_32x32x16_bf16 v[144:159], v[60:63], v[52:55], v[144:159]
    ds_read_b128 v[92:95], v31 offset:20480
    s_waitcnt lgkmcnt(4)
    v_mfma_f32_32x32x16_bf16 v[96:111], v[72:75], v[64:67], v[96:111]
    s_mov_b32 m0, s48
    s_nop 0
    buffer_load_dwordx4 v20, s[8:11], s35 offen offset:0 lds
    v_mfma_f32_32x32x16_bf16 v[112:127], v[76:79], v[64:67], v[112:127]
    buffer_load_dwordx4 v21, s[8:11], s35 offen offset:1024 lds
    v_mfma_f32_32x32x16_bf16 v[128:143], v[72:75], v[68:71], v[128:143]
    buffer_load_dwordx4 v22, s[8:11], s35 offen offset:2048 lds
    v_mfma_f32_32x32x16_bf16 v[144:159], v[76:79], v[68:71], v[144:159]
    buffer_load_dwordx4 v23, s[8:11], s35 offen offset:3072 lds
    s_add_u32 s34, s34, 128
    s_add_u32 s35, s35, 0x80
    s_waitcnt lgkmcnt(0)
    s_waitcnt vmcnt(16) lgkmcnt(0)
    s_barrier
    v_mfma_f32_32x32x16_bf16 v[96:111], v[88:91], v[80:83], v[96:111]
    ds_read_b128 v[32:35], v24 offset:32768
    ds_read_b128 v[36:39], v24 offset:36864
    v_mfma_f32_32x32x16_bf16 v[112:127], v[92:95], v[80:83], v[112:127]
    ds_read_b128 v[40:43], v28 offset:32768
    ds_read_b128 v[44:47], v28 offset:36864
    v_mfma_f32_32x32x16_bf16 v[128:143], v[88:91], v[84:87], v[128:143]
    ds_read_b128 v[48:51], v25 offset:32768
    ds_read_b128 v[52:55], v25 offset:36864
    v_mfma_f32_32x32x16_bf16 v[144:159], v[92:95], v[84:87], v[144:159]
    ds_read_b128 v[56:59], v29 offset:32768
    ds_read_b128 v[60:63], v29 offset:36864
    s_waitcnt lgkmcnt(4)
    v_mfma_f32_32x32x16_bf16 v[96:111], v[40:43], v[32:35], v[96:111]
    ds_read_b128 v[64:67], v26 offset:32768
    s_mov_b32 m0, s41
    s_nop 0
    buffer_load_dwordx4 v16, s[4:7], s34 offen offset:0 lds
    v_mfma_f32_32x32x16_bf16 v[112:127], v[44:47], v[32:35], v[112:127]
    ds_read_b128 v[68:71], v26 offset:36864
    v_mfma_f32_32x32x16_bf16 v[128:143], v[40:43], v[36:39], v[128:143]
    ds_read_b128 v[72:75], v30 offset:32768
    buffer_load_dwordx4 v17, s[4:7], s34 offen offset:1024 lds
    v_mfma_f32_32x32x16_bf16 v[144:159], v[44:47], v[36:39], v[144:159]
    ds_read_b128 v[76:79], v30 offset:36864
    s_waitcnt lgkmcnt(4)
    v_mfma_f32_32x32x16_bf16 v[96:111], v[56:59], v[48:51], v[96:111]
    ds_read_b128 v[80:83], v27 offset:32768
    buffer_load_dwordx4 v18, s[4:7], s34 offen offset:2048 lds
    v_mfma_f32_32x32x16_bf16 v[112:127], v[60:63], v[48:51], v[112:127]
    ds_read_b128 v[84:87], v27 offset:36864
    v_mfma_f32_32x32x16_bf16 v[128:143], v[56:59], v[52:55], v[128:143]
    ds_read_b128 v[88:91], v31 offset:32768
    buffer_load_dwordx4 v19, s[4:7], s34 offen offset:3072 lds
    v_mfma_f32_32x32x16_bf16 v[144:159], v[60:63], v[52:55], v[144:159]
    ds_read_b128 v[92:95], v31 offset:36864
    s_waitcnt lgkmcnt(4)
    v_mfma_f32_32x32x16_bf16 v[96:111], v[72:75], v[64:67], v[96:111]
    s_mov_b32 m0, s49
    s_nop 0
    buffer_load_dwordx4 v20, s[8:11], s35 offen offset:0 lds
    v_mfma_f32_32x32x16_bf16 v[112:127], v[76:79], v[64:67], v[112:127]
    buffer_load_dwordx4 v21, s[8:11], s35 offen offset:1024 lds
    v_mfma_f32_32x32x16_bf16 v[128:143], v[72:75], v[68:71], v[128:143]
    buffer_load_dwordx4 v22, s[8:11], s35 offen offset:2048 lds
    v_mfma_f32_32x32x16_bf16 v[144:159], v[76:79], v[68:71], v[144:159]
    buffer_load_dwordx4 v23, s[8:11], s35 offen offset:3072 lds
    s_add_u32 s34, s34, 128
    s_add_u32 s35, s35, 0x80
    s_waitcnt lgkmcnt(0)
    s_waitcnt vmcnt(16) lgkmcnt(0)
    s_barrier
    v_mfma_f32_32x32x16_bf16 v[96:111], v[88:91], v[80:83], v[96:111]
    ds_read_b128 v[32:35], v24 offset:49152
    ds_read_b128 v[36:39], v24 offset:53248
    v_mfma_f32_32x32x16_bf16 v[112:127], v[92:95], v[80:83], v[112:127]
    ds_read_b128 v[40:43], v28 offset:49152
    ds_read_b128 v[44:47], v28 offset:53248
    v_mfma_f32_32x32x16_bf16 v[128:143], v[88:91], v[84:87], v[128:143]
    ds_read_b128 v[48:51], v25 offset:49152
    ds_read_b128 v[52:55], v25 offset:53248
    v_mfma_f32_32x32x16_bf16 v[144:159], v[92:95], v[84:87], v[144:159]
    ds_read_b128 v[56:59], v29 offset:49152
    ds_read_b128 v[60:63], v29 offset:53248
    s_waitcnt lgkmcnt(4)
    v_mfma_f32_32x32x16_bf16 v[96:111], v[40:43], v[32:35], v[96:111]
    ds_read_b128 v[64:67], v26 offset:49152
    s_mov_b32 m0, s42
    s_nop 0
    buffer_load_dwordx4 v16, s[4:7], s34 offen offset:0 lds
    v_mfma_f32_32x32x16_bf16 v[112:127], v[44:47], v[32:35], v[112:127]
    ds_read_b128 v[68:71], v26 offset:53248
    v_mfma_f32_32x32x16_bf16 v[128:143], v[40:43], v[36:39], v[128:143]
    ds_read_b128 v[72:75], v30 offset:49152
    buffer_load_dwordx4 v17, s[4:7], s34 offen offset:1024 lds
    v_mfma_f32_32x32x16_bf16 v[144:159], v[44:47], v[36:39], v[144:159]
    ds_read_b128 v[76:79], v30 offset:53248
    s_waitcnt lgkmcnt(4)
    v_mfma_f32_32x32x16_bf16 v[96:111], v[56:59], v[48:51], v[96:111]
    ds_read_b128 v[80:83], v27 offset:49152
    buffer_load_dwordx4 v18, s[4:7], s34 offen offset:2048 lds
    v_mfma_f32_32x32x16_bf16 v[112:127], v[60:63], v[48:51], v[112:127]
    ds_read_b128 v[84:87], v27 offset:53248
    v_mfma_f32_32x32x16_bf16 v[128:143], v[56:59], v[52:55], v[128:143]
    ds_read_b128 v[88:91], v31 offset:49152
    buffer_load_dwordx4 v19, s[4:7], s34 offen offset:3072 lds
    v_mfma_f32_32x32x16_bf16 v[144:159], v[60:63], v[52:55], v[144:159]
    ds_read_b128 v[92:95], v31 offset:53248
    s_waitcnt lgkmcnt(4)
    v_mfma_f32_32x32x16_bf16 v[96:111], v[72:75], v[64:67], v[96:111]
    s_mov_b32 m0, s50
    s_nop 0
    buffer_load_dwordx4 v20, s[8:11], s35 offen offset:0 lds
    v_mfma_f32_32x32x16_bf16 v[112:127], v[76:79], v[64:67], v[112:127]
    buffer_load_dwordx4 v21, s[8:11], s35 offen offset:1024 lds
    v_mfma_f32_32x32x16_bf16 v[128:143], v[72:75], v[68:71], v[128:143]
    buffer_load_dwordx4 v22, s[8:11], s35 offen offset:2048 lds
    v_mfma_f32_32x32x16_bf16 v[144:159], v[76:79], v[68:71], v[144:159]
    buffer_load_dwordx4 v23, s[8:11], s35 offen offset:3072 lds
    s_add_u32 s34, s34, 128
    s_add_u32 s35, s35, 0x80
    s_waitcnt lgkmcnt(0)
    s_waitcnt vmcnt(16) lgkmcnt(0)
    s_barrier
    v_mfma_f32_32x32x16_bf16 v[96:111], v[88:91], v[80:83], v[96:111]
    ds_read_b128 v[32:35], v24 offset:0
    ds_read_b128 v[36:39], v24 offset:4096
    v_mfma_f32_32x32x16_bf16 v[112:127], v[92:95], v[80:83], v[112:127]
    ds_read_b128 v[40:43], v28 offset:0
    ds_read_b128 v[44:47], v28 offset:4096
    v_mfma_f32_32x32x16_bf16 v[128:143], v[88:91], v[84:87], v[128:143]
    ds_read_b128 v[48:51], v25 offset:0
    ds_read_b128 v[52:55], v25 offset:4096
    v_mfma_f32_32x32x16_bf16 v[144:159], v[92:95], v[84:87], v[144:159]
    ds_read_b128 v[56:59], v29 offset:0
    ds_read_b128 v[60:63], v29 offset:4096
    s_sub_u32 s36, s36, 1
    s_cmp_lg_u32 s36, 0
    s_cbranch_scc1 il_g2_kernel_loop_2
    s_waitcnt lgkmcnt(4)
    v_mfma_f32_32x32x16_bf16 v[96:111], v[40:43], v[32:35], v[96:111]
    ds_read_b128 v[64:67], v26 offset:0
    s_mov_b32 m0, s43
    s_nop 0
    buffer_load_dwordx4 v16, s[4:7], s34 offen offset:0 lds
    v_mfma_f32_32x32x16_bf16 v[112:127], v[44:47], v[32:35], v[112:127]
    ds_read_b128 v[68:71], v26 offset:4096
    v_mfma_f32_32x32x16_bf16 v[128:143], v[40:43], v[36:39], v[128:143]
    ds_read_b128 v[72:75], v30 offset:0
    buffer_load_dwordx4 v17, s[4:7], s34 offen offset:1024 lds
    v_mfma_f32_32x32x16_bf16 v[144:159], v[44:47], v[36:39], v[144:159]
    ds_read_b128 v[76:79], v30 offset:4096
    s_waitcnt lgkmcnt(4)
    v_mfma_f32_32x32x16_bf16 v[96:111], v[56:59], v[48:51], v[96:111]
    ds_read_b128 v[80:83], v27 offset:0
    buffer_load_dwordx4 v18, s[4:7], s34 offen offset:2048 lds
    v_mfma_f32_32x32x16_bf16 v[112:127], v[60:63], v[48:51], v[112:127]
    ds_read_b128 v[84:87], v27 offset:4096
    v_mfma_f32_32x32x16_bf16 v[128:143], v[56:59], v[52:55], v[128:143]
    ds_read_b128 v[88:91], v31 offset:0
    buffer_load_dwordx4 v19, s[4:7], s34 offen offset:3072 lds
    v_mfma_f32_32x32x16_bf16 v[144:159], v[60:63], v[52:55], v[144:159]
    ds_read_b128 v[92:95], v31 offset:4096
    s_waitcnt lgkmcnt(4)
    v_mfma_f32_32x32x16_bf16 v[96:111], v[72:75], v[64:67], v[96:111]
    s_mov_b32 m0, s51
    s_nop 0
    buffer_load_dwordx4 v20, s[8:11], s35 offen offset:0 lds
    v_mfma_f32_32x32x16_bf16 v[112:127], v[76:79], v[64:67], v[112:127]
    buffer_load_dwordx4 v21, s[8:11], s35 offen offset:1024 lds
    v_mfma_f32_32x32x16_bf16 v[128:143], v[72:75], v[68:71], v[128:143]
    buffer_load_dwordx4 v22, s[8:11], s35 offen offset:2048 lds
    v_mfma_f32_32x32x16_bf16 v[144:159], v[76:79], v[68:71], v[144:159]
    buffer_load_dwordx4 v23, s[8:11], s35 offen offset:3072 lds
    s_add_u32 s34, s34, 128
    s_add_u32 s35, s35, 0x80
    s_waitcnt lgkmcnt(0)
    s_waitcnt vmcnt(16) lgkmcnt(0)
    s_barrier
    v_mfma_f32_32x32x16_bf16 v[96:111], v[88:91], v[80:83], v[96:111]
    ds_read_b128 v[32:35], v24 offset:16384
    ds_read_b128 v[36:39], v24 offset:20480
    v_mfma_f32_32x32x16_bf16 v[112:127], v[92:95], v[80:83], v[112:127]
    ds_read_b128 v[40:43], v28 offset:16384
    ds_read_b128 v[44:47], v28 offset:20480
    v_mfma_f32_32x32x16_bf16 v[128:143], v[88:91], v[84:87], v[128:143]
    ds_read_b128 v[48:51], v25 offset:16384
    ds_read_b128 v[52:55], v25 offset:20480
    v_mfma_f32_32x32x16_bf16 v[144:159], v[92:95], v[84:87], v[144:159]
    ds_read_b128 v[56:59], v29 offset:16384
    ds_read_b128 v[60:63], v29 offset:20480
    s_waitcnt lgkmcnt(4)
    v_mfma_f32_32x32x16_bf16 v[96:111], v[40:43], v[32:35], v[96:111]
    ds_read_b128 v[64:67], v26 offset:16384
    v_mfma_f32_32x32x16_bf16 v[112:127], v[44:47], v[32:35], v[112:127]
    ds_read_b128 v[68:71], v26 offset:20480
    v_mfma_f32_32x32x16_bf16 v[128:143], v[40:43], v[36:39], v[128:143]
    ds_read_b128 v[72:75], v30 offset:16384
    v_mfma_f32_32x32x16_bf16 v[144:159], v[44:47], v[36:39], v[144:159]
    ds_read_b128 v[76:79], v30 offset:20480
    s_waitcnt lgkmcnt(4)
    v_mfma_f32_32x32x16_bf16 v[96:111], v[56:59], v[48:51], v[96:111]
    ds_read_b128 v[80:83], v27 offset:16384
    v_mfma_f32_32x32x16_bf16 v[112:127], v[60:63], v[48:51], v[112:127]
    ds_read_b128 v[84:87], v27 offset:20480
    v_mfma_f32_32x32x16_bf16 v[128:143], v[56:59], v[52:55], v[128:143]
    ds_read_b128 v[88:91], v31 offset:16384
    v_mfma_f32_32x32x16_bf16 v[144:159], v[60:63], v[52:55], v[144:159]
    ds_read_b128 v[92:95], v31 offset:20480
    s_waitcnt lgkmcnt(4)
    v_mfma_f32_32x32x16_bf16 v[96:111], v[72:75], v[64:67], v[96:111]
    v_mfma_f32_32x32x16_bf16 v[112:127], v[76:79], v[64:67], v[112:127]
    v_mfma_f32_32x32x16_bf16 v[128:143], v[72:75], v[68:71], v[128:143]
    v_mfma_f32_32x32x16_bf16 v[144:159], v[76:79], v[68:71], v[144:159]
    s_waitcnt lgkmcnt(0)
    s_waitcnt vmcnt(8) lgkmcnt(0)
    s_barrier
    v_mfma_f32_32x32x16_bf16 v[96:111], v[88:91], v[80:83], v[96:111]
    ds_read_b128 v[32:35], v24 offset:32768
    ds_read_b128 v[36:39], v24 offset:36864
    v_mfma_f32_32x32x16_bf16 v[112:127], v[92:95], v[80:83], v[112:127]
    ds_read_b128 v[40:43], v28 offset:32768
    ds_read_b128 v[44:47], v28 offset:36864
    v_mfma_f32_32x32x16_bf16 v[128:143], v[88:91], v[84:87], v[128:143]
    ds_read_b128 v[48:51], v25 offset:32768
    ds_read_b128 v[52:55], v25 offset:36864
    v_mfma_f32_32x32x16_bf16 v[144:159], v[92:95], v[84:87], v[144:159]
    ds_read_b128 v[56:59], v29 offset:32768
    ds_read_b128 v[60:63], v29 offset:36864
    s_waitcnt lgkmcnt(4)
    v_mfma_f32_32x32x16_bf16 v[96:111], v[40:43], v[32:35], v[96:111]
    ds_read_b128 v[64:67], v26 offset:32768
    v_mfma_f32_32x32x16_bf16 v[112:127], v[44:47], v[32:35], v[112:127]
    ds_read_b128 v[68:71], v26 offset:36864
    v_mfma_f32_32x32x16_bf16 v[128:143], v[40:43], v[36:39], v[128:143]
    ds_read_b128 v[72:75], v30 offset:32768
    v_mfma_f32_32x32x16_bf16 v[144:159], v[44:47], v[36:39], v[144:159]
    ds_read_b128 v[76:79], v30 offset:36864
    s_waitcnt lgkmcnt(4)
    v_mfma_f32_32x32x16_bf16 v[96:111], v[56:59], v[48:51], v[96:111]
    ds_read_b128 v[80:83], v27 offset:32768
    v_mfma_f32_32x32x16_bf16 v[112:127], v[60:63], v[48:51], v[112:127]
    ds_read_b128 v[84:87], v27 offset:36864
    v_mfma_f32_32x32x16_bf16 v[128:143], v[56:59], v[52:55], v[128:143]
    ds_read_b128 v[88:91], v31 offset:32768
    v_mfma_f32_32x32x16_bf16 v[144:159], v[60:63], v[52:55], v[144:159]
    ds_read_b128 v[92:95], v31 offset:36864
    s_waitcnt lgkmcnt(4)
    v_mfma_f32_32x32x16_bf16 v[96:111], v[72:75], v[64:67], v[96:111]
    v_mfma_f32_32x32x16_bf16 v[112:127], v[76:79], v[64:67], v[112:127]
    v_mfma_f32_32x32x16_bf16 v[128:143], v[72:75], v[68:71], v[128:143]
    v_mfma_f32_32x32x16_bf16 v[144:159], v[76:79], v[68:71], v[144:159]
    s_waitcnt lgkmcnt(0)
    s_waitcnt vmcnt(0) lgkmcnt(0)
    s_barrier
    v_mfma_f32_32x32x16_bf16 v[96:111], v[88:91], v[80:83], v[96:111]
    ds_read_b128 v[32:35], v24 offset:49152
    ds_read_b128 v[36:39], v24 offset:53248
    v_mfma_f32_32x32x16_bf16 v[112:127], v[92:95], v[80:83], v[112:127]
    ds_read_b128 v[40:43], v28 offset:49152
    ds_read_b128 v[44:47], v28 offset:53248
    v_mfma_f32_32x32x16_bf16 v[128:143], v[88:91], v[84:87], v[128:143]
    ds_read_b128 v[48:51], v25 offset:49152
    ds_read_b128 v[52:55], v25 offset:53248
    v_mfma_f32_32x32x16_bf16 v[144:159], v[92:95], v[84:87], v[144:159]
    ds_read_b128 v[56:59], v29 offset:49152
    ds_read_b128 v[60:63], v29 offset:53248
    s_waitcnt lgkmcnt(4)
    v_mfma_f32_32x32x16_bf16 v[96:111], v[40:43], v[32:35], v[96:111]
    ds_read_b128 v[64:67], v26 offset:49152
    v_mfma_f32_32x32x16_bf16 v[112:127], v[44:47], v[32:35], v[112:127]
    ds_read_b128 v[68:71], v26 offset:53248
    v_mfma_f32_32x32x16_bf16 v[128:143], v[40:43], v[36:39], v[128:143]
    ds_read_b128 v[72:75], v30 offset:49152
    v_mfma_f32_32x32x16_bf16 v[144:159], v[44:47], v[36:39], v[144:159]
    ds_read_b128 v[76:79], v30 offset:53248
    s_waitcnt lgkmcnt(4)
    v_mfma_f32_32x32x16_bf16 v[96:111], v[56:59], v[48:51], v[96:111]
    ds_read_b128 v[80:83], v27 offset:49152
    v_mfma_f32_32x32x16_bf16 v[112:127], v[60:63], v[48:51], v[112:127]
    ds_read_b128 v[84:87], v27 offset:53248
    v_mfma_f32_32x32x16_bf16 v[128:143], v[56:59], v[52:55], v[128:143]
    ds_read_b128 v[88:91], v31 offset:49152
    v_mfma_f32_32x32x16_bf16 v[144:159], v[60:63], v[52:55], v[144:159]
    ds_read_b128 v[92:95], v31 offset:53248
    s_waitcnt lgkmcnt(4)
    v_mfma_f32_32x32x16_bf16 v[96:111], v[72:75], v[64:67], v[96:111]
    v_mfma_f32_32x32x16_bf16 v[112:127], v[76:79], v[64:67], v[112:127]
    v_mfma_f32_32x32x16_bf16 v[128:143], v[72:75], v[68:71], v[128:143]
    v_mfma_f32_32x32x16_bf16 v[144:159], v[76:79], v[68:71], v[144:159]
    s_waitcnt lgkmcnt(0)
    v_mfma_f32_32x32x16_bf16 v[96:111], v[88:91], v[80:83], v[96:111]
    v_mfma_f32_32x32x16_bf16 v[112:127], v[92:95], v[80:83], v[112:127]
    v_mfma_f32_32x32x16_bf16 v[128:143], v[88:91], v[84:87], v[128:143]
    v_mfma_f32_32x32x16_bf16 v[144:159], v[92:95], v[84:87], v[144:159]
    s_nop 15
    s_nop 3
    s_barrier
    s_mul_i32 s23, s20, 8192
    v_and_b32 v10, 7, v8
    v_lshlrev_b32 v10, 4, v10
    v_lshl_add_u32 v10, v9, 3, v10
    v_mul_u32_u24 v13, 128, v8
    v_add_u32 v10, v10, v13
    v_add_u32 v10, s23, v10
    v_lshrrev_b32 v13, 3, v2
    v_and_b32 v14, 7, v2
    v_and_b32 v15, 7, v13
    v_xor_b32 v15, v15, v14
    v_lshlrev_b32 v15, 4, v15
    v_mul_u32_u24 v11, 128, v13
    v_add_u32 v11, v11, v15
    v_add_u32 v11, s23, v11
    s_mul_i32 s23, s21, 64
    v_add_u32 v13, s23, v13
    v_mul_u32_u24 v12, 0x800, v13
    v_lshl_add_u32 v12, v14, 4, v12
    s_mul_i32 s23, s22, 128
    v_add_u32 v12, s23, v12
    v_cvt_pk_bf16_f32 v96, v96, v97
    v_cvt_pk_bf16_f32 v97, v98, v99
    ds_write_b64 v10, v[96:97] offset:0
    v_cvt_pk_bf16_f32 v100, v100, v101
    v_cvt_pk_bf16_f32 v101, v102, v103
    v_xor_b32 v13, 0x10, v10
    ds_write_b64 v13, v[100:101] offset:0
    v_cvt_pk_bf16_f32 v104, v104, v105
    v_cvt_pk_bf16_f32 v105, v106, v107
    v_xor_b32 v13, 0x20, v10
    ds_write_b64 v13, v[104:105] offset:0
    v_cvt_pk_bf16_f32 v108, v108, v109
    v_cvt_pk_bf16_f32 v109, v110, v111
    v_xor_b32 v13, 0x30, v10
    ds_write_b64 v13, v[108:109] offset:0
    v_cvt_pk_bf16_f32 v112, v112, v113
    v_cvt_pk_bf16_f32 v113, v114, v115
    v_xor_b32 v13, 0x40, v10
    ds_write_b64 v13, v[112:113] offset:0
    v_cvt_pk_bf16_f32 v116, v116, v117
    v_cvt_pk_bf16_f32 v117, v118, v119
    v_xor_b32 v13, 0x50, v10
    ds_write_b64 v13, v[116:117] offset:0
    v_cvt_pk_bf16_f32 v120, v120, v121
    v_cvt_pk_bf16_f32 v121, v122, v123
    v_xor_b32 v13, 0x60, v10
    ds_write_b64 v13, v[120:121] offset:0
    v_cvt_pk_bf16_f32 v124, v124, v125
    v_cvt_pk_bf16_f32 v125, v126, v127
    v_xor_b32 v13, 0x70, v10
    ds_write_b64 v13, v[124:125] offset:0
    v_cvt_pk_bf16_f32 v128, v128, v129
    v_cvt_pk_bf16_f32 v129, v130, v131
    ds_write_b64 v10, v[128:129] offset:4096
    v_cvt_pk_bf16_f32 v132, v132, v133
    v_cvt_pk_bf16_f32 v133, v134, v135
    v_xor_b32 v13, 0x10, v10
    ds_write_b64 v13, v[132:133] offset:4096
    v_cvt_pk_bf16_f32 v136, v136, v137
    v_cvt_pk_bf16_f32 v137, v138, v139
    v_xor_b32 v13, 0x20, v10
    ds_write_b64 v13, v[136:137] offset:4096
    v_cvt_pk_bf16_f32 v140, v140, v141
    v_cvt_pk_bf16_f32 v141, v142, v143
    v_xor_b32 v13, 0x30, v10
    ds_write_b64 v13, v[140:141] offset:4096
    v_cvt_pk_bf16_f32 v144, v144, v145
    v_cvt_pk_bf16_f32 v145, v146, v147
    v_xor_b32 v13, 0x40, v10
    ds_write_b64 v13, v[144:145] offset:4096
    v_cvt_pk_bf16_f32 v148, v148, v149
    v_cvt_pk_bf16_f32 v149, v150, v151
    v_xor_b32 v13, 0x50, v10
    ds_write_b64 v13, v[148:149] offset:4096
    v_cvt_pk_bf16_f32 v152, v152, v153
    v_cvt_pk_bf16_f32 v153, v154, v155
    v_xor_b32 v13, 0x60, v10
    ds_write_b64 v13, v[152:153] offset:4096
    v_cvt_pk_bf16_f32 v156, v156, v157
    v_cvt_pk_bf16_f32 v157, v158, v159
    v_xor_b32 v13, 0x70, v10
    ds_write_b64 v13, v[156:157] offset:4096
    s_waitcnt lgkmcnt(0)
    ds_read_b128 v[96:99], v11 offset:0
    ds_read_b128 v[100:103], v11 offset:1024
    ds_read_b128 v[104:107], v11 offset:2048
    ds_read_b128 v[108:111], v11 offset:3072
    ds_read_b128 v[112:115], v11 offset:4096
    ds_read_b128 v[116:119], v11 offset:5120
    ds_read_b128 v[120:123], v11 offset:6144
    ds_read_b128 v[124:127], v11 offset:7168
    s_waitcnt lgkmcnt(7)
    buffer_store_dwordx4 v[96:99], v12, s[12:15], 0 offen sc1
    v_add_u32 v12, 0x4000, v12
    s_waitcnt lgkmcnt(6)
    buffer_store_dwordx4 v[100:103], v12, s[12:15], 0 offen sc1
    v_add_u32 v12, 0x4000, v12
    s_waitcnt lgkmcnt(5)
    buffer_store_dwordx4 v[104:107], v12, s[12:15], 0 offen sc1
    v_add_u32 v12, 0x4000, v12
    s_waitcnt lgkmcnt(4)
    buffer_store_dwordx4 v[108:111], v12, s[12:15], 0 offen sc1
    v_add_u32 v12, 0x4000, v12
    s_waitcnt lgkmcnt(3)
    buffer_store_dwordx4 v[112:115], v12, s[12:15], 0 offen sc1
    v_add_u32 v12, 0x4000, v12
    s_waitcnt lgkmcnt(2)
    buffer_store_dwordx4 v[116:119], v12, s[12:15], 0 offen sc1
    v_add_u32 v12, 0x4000, v12
    s_waitcnt lgkmcnt(1)
    buffer_store_dwordx4 v[120:123], v12, s[12:15], 0 offen sc1
    v_add_u32 v12, 0x4000, v12
    s_waitcnt lgkmcnt(0)
    buffer_store_dwordx4 v[124:127], v12, s[12:15], 0 offen sc1
il_g2_kernel_end_1:
    s_endpgm
.globl il_g3_kernel
.p2align 8
.type il_g3_kernel,@function
il_g3_kernel:
    s_cmp_ge_u32 s2, 224
    s_cbranch_scc1 il_g3_kernel_end_1
    s_load_dwordx2 s[38:39], s[0:1], 88
    s_load_dwordx2 s[28:29], s[0:1], 48
    s_load_dwordx2 s[30:31], s[0:1], 56
    s_and_b32 s23, s2, 7
    s_lshr_b32 s3, s2, 3
    s_mul_i32 s16, s23, 28
    s_add_u32 s16, s16, s3
    s_mov_b32 s19, 0
    s_and_b32 s17, s16, 7
    s_lshr_b32 s18, s16, 3
    v_lshrrev_b32 v1, 6, v0
    v_and_b32 v2, 63, v0
    s_nop 0
    v_readfirstlane_b32 s20, v1
    s_nop 3
    s_lshr_b32 s21, s20, 1
    s_and_b32 s22, s20, 1
    s_waitcnt lgkmcnt(0)
    s_mul_i32 s23, s17, 256
    s_mul_i32 s3, s20, 32
    s_add_u32 s23, s23, s3
    s_mul_i32 s23, s23, 2048
    s_add_u32 s4, s38, s23
    s_addc_u32 s5, s39, 0
    s_add_u32 s4, s4, 0x400000
    s_addc_u32 s5, s5, 0
    s_sub_u32 s6, 0x400000, s23
    s_and_b32 s5, s5, 0xffff
    s_mov_b32 s7, 0x20000
    s_mul_i32 s23, s20, 4
    s_and_b32 s3, s23, 7
    s_lshr_b32 s23, s23, 3
    s_mul_i32 s3, s3, 57344
    s_cmp_lt_u32 s23, 2
    s_cselect_b32 s28, s28, s30
    s_cselect_b32 s29, s29, s31
    s_and_b32 s23, s23, 1
    s_mul_i32 s23, s23, 128
    s_add_u32 s23, s23, s3
    s_mul_i32 s3, s18, 256
    s_add_u32 s23, s23, s3
    s_add_u32 s8, s28, s23
    s_addc_u32 s9, s29, 0
    s_sub_u32 s10, 0x700000, s23
    s_and_b32 s9, s9, 0xffff
    s_mov_b32 s11, 0x20000
    s_mul_i32 s23, s17, 1835008
    s_mul_i32 s3, s18, 256
    s_add_u32 s23, s23, s3
    s_add_u32 s12, s38, s23
    s_addc_u32 s13, s39, 0
    s_add_u32 s12, s12, 0x1800000
    s_addc_u32 s13, s13, 0
    s_sub_u32 s14, 0xe00000, s23
    s_and_b32 s13, s13, 0xffff
    s_mov_b32 s15, 0x20000
    v_lshrrev_b32 v3, 3, v2
    v_and_b32 v4, 7, v2
    v_lshrrev_b32 v5, 4, v2
    v_mul_u32_u24 v6, 0x800, v3
    v_xor_b32 v7, v5, v4
    v_lshl_add_u32 v16, v7, 4, v6
    v_or_b32 v7, 4, v5
    v_xor_b32 v7, v7, v4
    v_lshl_add_u32 v17, v7, 4, v6
    v_add_u32 v17, 0x3c00, v17
    v_xor_b32 v7, v5, v4
    v_lshl_add_u32 v18, v7, 4, v6
    v_add_u32 v18, 0x7800, v18
    v_or_b32 v7, 4, v5
    v_xor_b32 v7, v7, v4
    v_lshl_add_u32 v19, v7, 4, v6
    v_add_u32 v19, 0xb400, v19
    v_and_b32 v7, 1, v5
    v_lshlrev_b32 v7, 2, v7
    v_xor_b32 v7, v7, v4
    v_mul_u32_u24 v6, 0x1c00, v3
    v_lshl_add_u32 v20, v7, 4, v6
    v_lshl_add_u32 v21, v7, 4, v6
    v_add_u32 v21, 0xdc00, v21
    v_lshl_add_u32 v22, v7, 4, v6
    v_add_u32 v22, 0x1b800, v22
    v_lshl_add_u32 v23, v7, 4, v6
    v_add_u32 v23, 0x29400, v23
    v_and_b32 v8, 31, v2
    v_lshrrev_b32 v9, 5, v2
    v_lshrrev_b32 v10, 1, v8
    v_and_b32 v10, 7, v10
    v_xor_b32 v10, v10, v9
    v_lshlrev_b32 v10, 4, v10
    v_lshl_add_u32 v10, v8, 7, v10
    s_mul_i32 s23, s21, 8192
    v_xor_b32 v24, 0x0, v10
    v_add_u32 v24, s23, v24
    v_xor_b32 v25, 0x20, v10
    v_add_u32 v25, s23, v25
    v_xor_b32 v26, 0x40, v10
    v_add_u32 v26, s23, v26
    v_xor_b32 v27, 0x60, v10
    v_add_u32 v27, s23, v27
    v_lshrrev_b32 v11, 2, v2
    v_and_b32 v11, 3, v11
    v_lshl_add_u32 v11, v9, 3, v11
    v_and_b32 v12, 1, v5
    v_lshlrev_b32 v12, 1, v12
    v_lshrrev_b32 v13, 1, v2
    v_and_b32 v13, 1, v13
    v_add_u32 v12, v12, v13
    v_and_b32 v13, 1, v3
    v_lshlrev_b32 v13, 2, v13
    v_and_b32 v14, 1, v2
    s_mul_i32 s23, s22, 2
    s_add_u32 s23, s23, 0
    s_and_b32 s3, s23, 1
    s_lshl_b32 s3, s3, 2
    v_add_u32 v15, s3, v12
    v_xor_b32 v15, v15, v13
    v_lshlrev_b32 v15, 4, v15
    v_lshl_add_u32 v15, v11, 7, v15
    v_lshl_add_u32 v15, v14, 3, v15
    s_lshr_b32 s23, s23, 1
    s_lshl_b32 s23, s23, 13
    s_add_u32 s23, s23, 0x10000
    v_add_u32 v28, s23, v15
    s_mul_i32 s23, s22, 2
    s_add_u32 s23, s23, 1
    s_and_b32 s3, s23, 1
    s_lshl_b32 s3, s3, 2
    v_add_u32 v15, s3, v12
    v_xor_b32 v15, v15, v13
    v_lshlrev_b32 v15, 4, v15
    v_lshl_add_u32 v15, v11, 7, v15
    v_lshl_add_u32 v15, v14, 3, v15
    s_lshr_b32 s23, s23, 1
    s_lshl_b32 s23, s23, 13
    s_add_u32 s23, s23, 0x10000
    v_add_u32 v29, s23, v15
    s_mul_i32 s23, s22, 2
    s_add_u32 s23, s23, 0
    s_and_b32 s3, s23, 1
    s_lshl_b32 s3, s3, 2
    v_add_u32 v15, s3, v12
    v_xor_b32 v15, v15, v13
    v_lshlrev_b32 v15, 4, v15
    v_lshl_add_u32 v15, v11, 7, v15
    v_lshl_add_u32 v15, v14, 3, v15
    s_lshr_b32 s23, s23, 1
    s_lshl_b32 s23, s23, 13
    s_add_u32 s23, s23, 0x14000
    v_add_u32 v30, s23, v15
    s_mul_i32 s23, s22, 2
    s_add_u32 s23, s23, 1
    s_and_b32 s3, s23, 1
    s_lshl_b32 s3, s3, 2
    v_add_u32 v15, s3, v12
    v_xor_b32 v15, v15, v13
    v_lshlrev_b32 v15, 4, v15
    v_lshl_add_u32 v15, v11, 7, v15
    v_lshl_add_u32 v15, v14, 3, v15
    s_lshr_b32 s23, s23, 1
    s_lshl_b32 s23, s23, 13
    s_add_u32 s23, s23, 0x14000
    v_add_u32 v31, s23, v15
    s_mul_i32 s23, s20, 4096
    s_add_u32 s40, s23, 0x0
    s_mul_i32 s23, s20, 4096
    s_add_u32 s48, s23, 0x10000
    s_mul_i32 s23, s20, 4096
    s_add_u32 s41, s23, 0x8000
    s_mul_i32 s23, s20, 4096
    s_add_u32 s49, s23, 0x18000
    s_mov_b32 s34, 0
    s_mov_b32 s35, 0
    s_mov_b32 m0, s40
    s_nop 0
    buffer_load_dwordx4 v16, s[4:7], s34 offen offset:0 lds
    buffer_load_dwordx4 v17, s[4:7], s34 offen offset:1024 lds
    buffer_load_dwordx4 v18, s[4:7], s34 offen offset:2048 lds
    buffer_load_dwordx4 v19, s[4:7], s34 offen offset:3072 lds
    s_mov_b32 m0, s48
    s_nop 0
    buffer_load_dwordx4 v20, s[8:11], s35 offen offset:0 lds
    buffer_load_dwordx4 v21, s[8:11], s35 offen offset:1024 lds
    buffer_load_dwordx4 v22, s[8:11], s35 offen offset:2048 lds
    buffer_load_dwordx4 v23, s[8:11], s35 offen offset:3072 lds
    s_add_u32 s34, s34, 128
    s_add_u32 s35, s35, 0x70000
    v_mov_b32 v128, 0
    v_mov_b32 v129, 0
    v_mov_b32 v130, 0
    v_mov_b32 v131, 0
    v_mov_b32 v132, 0
    v_mov_b32 v133, 0
    v_mov_b32 v134, 0
    v_mov_b32 v135, 0
    v_mov_b32 v136, 0
    v_mov_b32 v137, 0
    v_mov_b32 v138, 0
    v_mov_b32 v139, 0
    v_mov_b32 v140, 0
    v_mov_b32 v141, 0
    v_mov_b32 v142, 0
    v_mov_b32 v143, 0
    v_mov_b32 v144, 0
    v_mov_b32 v145, 0
    v_mov_b32 v146, 0
    v_mov_b32 v147, 0
    v_mov_b32 v148, 0
    v_mov_b32 v149, 0
    v_mov_b32 v150, 0
    v_mov_b32 v151, 0
    v_mov_b32 v152, 0
    v_mov_b32 v153, 0
    v_mov_b32 v154, 0
    v_mov_b32 v155, 0
    v_mov_b32 v156, 0
    v_mov_b32 v157, 0
    v_mov_b32 v158, 0
    v_mov_b32 v159, 0
    v_mov_b32 v160, 0
    v_mov_b32 v161, 0
    v_mov_b32 v162, 0
    v_mov_b32 v163, 0
    v_mov_b32 v164, 0
    v_mov_b32 v165, 0
    v_mov_b32 v166, 0
    v_mov_b32 v167, 0
    v_mov_b32 v168, 0
    v_mov_b32 v169, 0
    v_mov_b32 v170, 0
    v_mov_b32 v171, 0
    v_mov_b32 v172, 0
    v_mov_b32 v173, 0
    v_mov_b32 v174, 0
    v_mov_b32 v175, 0
    v_mov_b32 v176, 0
    v_mov_b32 v177, 0
    v_mov_b32 v178, 0
    v_mov_b32 v179, 0
    v_mov_b32 v180, 0
    v_mov_b32 v181, 0
    v_mov_b32 v182, 0
    v_mov_b32 v183, 0
    v_mov_b32 v184, 0
    v_mov_b32 v185, 0
    v_mov_b32 v186, 0
    v_mov_b32 v187, 0
    v_mov_b32 v188, 0
    v_mov_b32 v189, 0
    v_mov_b32 v190, 0
    v_mov_b32 v191, 0
    v_mov_b32 v192, 0
    v_mov_b32 v193, 0
    v_mov_b32 v194, 0
    v_mov_b32 v195, 0
    v_mov_b32 v196, 0
    v_mov_b32 v197, 0
    v_mov_b32 v198, 0
    v_mov_b32 v199, 0
    v_mov_b32 v200, 0
    v_mov_b32 v201, 0
    v_mov_b32 v202, 0
    v_mov_b32 v203, 0
    v_mov_b32 v204, 0
    v_mov_b32 v205, 0
    v_mov_b32 v206, 0
    v_mov_b32 v207, 0
    v_mov_b32 v208, 0
    v_mov_b32 v209, 0
    v_mov_b32 v210, 0
    v_mov_b32 v211, 0
    v_mov_b32 v212, 0
    v_mov_b32 v213, 0
    v_mov_b32 v214, 0
    v_mov_b32 v215, 0
    v_mov_b32 v216, 0
    v_mov_b32 v217, 0
    v_mov_b32 v218, 0
    v_mov_b32 v219, 0
    v_mov_b32 v220, 0
    v_mov_b32 v221, 0
    v_mov_b32 v222, 0
    v_mov_b32 v223, 0
    v_mov_b32 v224, 0
    v_mov_b32 v225, 0
    v_mov_b32 v226, 0
    v_mov_b32 v227, 0
    v_mov_b32 v228, 0
    v_mov_b32 v229, 0
    v_mov_b32 v230, 0
    v_mov_b32 v231, 0
    v_mov_b32 v232, 0
    v_mov_b32 v233, 0
    v_mov_b32 v234, 0
    v_mov_b32 v235, 0
    v_mov_b32 v236, 0
    v_mov_b32 v237, 0
    v_mov_b32 v238, 0
    v_mov_b32 v239, 0
    v_mov_b32 v240, 0
    v_mov_b32 v241, 0
    v_mov_b32 v242, 0
    v_mov_b32 v243, 0
    v_mov_b32 v244, 0
    v_mov_b32 v245, 0
    v_mov_b32 v246, 0
    v_mov_b32 v247, 0
    v_mov_b32 v248, 0
    v_mov_b32 v249, 0
    v_mov_b32 v250, 0
    v_mov_b32 v251, 0
    v_mov_b32 v252, 0
    v_mov_b32 v253, 0
    v_mov_b32 v254, 0
    v_mov_b32 v255, 0
    s_waitcnt vmcnt(0)
    s_barrier
    ds_read_b128 v[32:35], v24 offset:0
    ds_read_b128 v[36:39], v24 offset:4096
    ds_read_b64_tr_b16 v[40:41], v28 offset:0
    ds_read_b64_tr_b16 v[42:43], v28 offset:512
    ds_read_b64_tr_b16 v[44:45], v29 offset:0
    ds_read_b64_tr_b16 v[46:47], v29 offset:512
    ds_read_b64_tr_b16 v[48:49], v30 offset:0
    ds_read_b64_tr_b16 v[50:51], v30 offset:512
    ds_read_b64_tr_b16 v[52:53], v31 offset:0
    ds_read_b64_tr_b16 v[54:55], v31 offset:512
    ds_read_b128 v[56:59], v25 offset:0
    ds_read_b128 v[60:63], v25 offset:4096
    ds_read_b64_tr_b16 v[64:65], v28 offset:2048
    ds_read_b64_tr_b16 v[66:67], v28 offset:2560
    ds_read_b64_tr_b16 v[68:69], v29 offset:2048
    ds_read_b64_tr_b16 v[70:71], v29 offset:2560
    ds_read_b64_tr_b16 v[72:73], v30 offset:2048
    ds_read_b64_tr_b16 v[74:75], v30 offset:2560
    ds_read_b64_tr_b16 v[76:77], v31 offset:2048
    ds_read_b64_tr_b16 v[78:79], v31 offset:2560
    s_mov_b32 s36, 7
il_g3_kernel_loop_2:
    s_waitcnt lgkmcnt(10)
    v_mfma_f32_32x32x16_bf16 v[128:143], v[40:43], v[32:35], v[128:143]
    ds_read_b128 v[80:83], v26 offset:0
    s_mov_b32 m0, s41
    s_nop 0
    buffer_load_dwordx4 v16, s[4:7], s34 offen offset:0 lds
    ds_read_b128 v[84:87], v26 offset:4096
    v_mfma_f32_32x32x16_bf16 v[144:159], v[44:47], v[32:35], v[144:159]
    buffer_load_dwordx4 v17, s[4:7], s34 offen offset:1024 lds
    ds_read_b64_tr_b16 v[88:89], v28 offset:4096
    v_mfma_f32_32x32x16_bf16 v[160:175], v[48:51], v[32:35], v[160:175]
    buffer_load_dwordx4 v18, s[4:7], s34 offen offset:2048 lds
    ds_read_b64_tr_b16 v[90:91], v28 offset:4608
    v_mfma_f32_32x32x16_bf16 v[176:191], v[52:55], v[32:35], v[176:191]
    buffer_load_dwordx4 v19, s[4:7], s34 offen offset:3072 lds
    ds_read_b64_tr_b16 v[92:93], v29 offset:4096
    v_mfma_f32_32x32x16_bf16 v[192:207], v[40:43], v[36:39], v[192:207]
    ds_read_b64_tr_b16 v[94:95], v29 offset:4608
    s_mov_b32 m0, s49
    s_nop 0
    buffer_load_dwordx4 v20, s[8:11], s35 offen offset:0 lds
    ds_read_b64_tr_b16 v[96:97], v30 offset:4096
    v_mfma_f32_32x32x16_bf16 v[208:223], v[44:47], v[36:39], v[208:223]
    buffer_load_dwordx4 v21, s[8:11], s35 offen offset:1024 lds
    ds_read_b64_tr_b16 v[98:99], v30 offset:4608
    v_mfma_f32_32x32x16_bf16 v[224:239], v[48:51], v[36:39], v[224:239]
    buffer_load_dwordx4 v22, s[8:11], s35 offen offset:2048 lds
    ds_read_b64_tr_b16 v[100:101], v31 offset:4096
    v_mfma_f32_32x32x16_bf16 v[240:255], v[52:55], v[36:39], v[240:255]
    buffer_load_dwordx4 v23, s[8:11], s35 offen offset:3072 lds
    ds_read_b64_tr_b16 v[102:103], v31 offset:4608
    s_waitcnt lgkmcnt(10)
    v_mfma_f32_32x32x16_bf16 v[128:143], v[64:67], v[56:59], v[128:143]
    ds_read_b128 v[104:107], v27 offset:0
    ds_read_b128 v[108:111], v27 offset:4096
    v_mfma_f32_32x32x16_bf16 v[144:159], v[68:71], v[56:59], v[144:159]
    ds_read_b64_tr_b16 v[112:113], v28 offset:6144
    v_mfma_f32_32x32x16_bf16 v[160:175], v[72:75], v[56:59], v[160:175]
    ds_read_b64_tr_b16 v[114:115], v28 offset:6656
    v_mfma_f32_32x32x16_bf16 v[176:191], v[76:79], v[56:59], v[176:191]
    ds_read_b64_tr_b16 v[116:117], v29 offset:6144
    v_mfma_f32_32x32x16_bf16 v[192:207], v[64:67], v[60:63], v[192:207]
    ds_read_b64_tr_b16 v[118:119], v29 offset:6656
    ds_read_b64_tr_b16 v[120:121], v30 offset:6144
    v_mfma_f32_32x32x16_bf16 v[208:223], v[68:71], v[60:63], v[208:223]
    ds_read_b64_tr_b16 v[122:123], v30 offset:6656
    v_mfma_f32_32x32x16_bf16 v[224:239], v[72:75], v[60:63], v[224:239]
    ds_read_b64_tr_b16 v[124:125], v31 offset:6144
    v_mfma_f32_32x32x16_bf16 v[240:255], v[76:79], v[60:63], v[240:255]
    ds_read_b64_tr_b16 v[126:127], v31 offset:6656
    s_waitcnt lgkmcnt(10)
    v_mfma_f32_32x32x16_bf16 v[128:143], v[88:91], v[80:83], v[128:143]
    v_mfma_f32_32x32x16_bf16 v[144:159], v[92:95], v[80:83], v[144:159]
    v_mfma_f32_32x32x16_bf16 v[160:175], v[96:99], v[80:83], v[160:175]
    v_mfma_f32_32x32x16_bf16 v[176:191], v[100:103], v[80:83], v[176:191]
    v_mfma_f32_32x32x16_bf16 v[192:207], v[88:91], v[84:87], v[192:207]
    v_mfma_f32_32x32x16_bf16 v[208:223], v[92:95], v[84:87], v[208:223]
    v_mfma_f32_32x32x16_bf16 v[224:239], v[96:99], v[84:87], v[224:239]
    v_mfma_f32_32x32x16_bf16 v[240:255], v[100:103], v[84:87], v[240:255]
    s_add_u32 s34, s34, 128
    s_add_u32 s35, s35, 0x70000
    s_waitcnt lgkmcnt(0)
    s_waitcnt vmcnt(0) lgkmcnt(0)
    s_barrier
    v_mfma_f32_32x32x16_bf16 v[128:143], v[112:115], v[104:107], v[128:143]
    ds_read_b128 v[32:35], v24 offset:32768
    ds_read_b128 v[36:39], v24 offset:36864
    ds_read_b64_tr_b16 v[40:41], v28 offset:32768
    v_mfma_f32_32x32x16_bf16 v[144:159], v[116:119], v[104:107], v[144:159]
    ds_read_b64_tr_b16 v[42:43], v28 offset:33280
    ds_read_b64_tr_b16 v[44:45], v29 offset:32768
    v_mfma_f32_32x32x16_bf16 v[160:175], v[120:123], v[104:107], v[160:175]
    ds_read_b64_tr_b16 v[46:47], v29 offset:33280
    ds_read_b64_tr_b16 v[48:49], v30 offset:32768
    ds_read_b64_tr_b16 v[50:51], v30 offset:33280
    v_mfma_f32_32x32x16_bf16 v[176:191], v[124:127], v[104:107], v[176:191]
    ds_read_b64_tr_b16 v[52:53], v31 offset:32768
    ds_read_b64_tr_b16 v[54:55], v31 offset:33280
    v_mfma_f32_32x32x16_bf16 v[192:207], v[112:115], v[108:111], v[192:207]
    ds_read_b128 v[56:59], v25 offset:32768
    ds_read_b128 v[60:63], v25 offset:36864
    ds_read_b64_tr_b16 v[64:65], v28 offset:34816
    v_mfma_f32_32x32x16_bf16 v[208:223], v[116:119], v[108:111], v[208:223]
    ds_read_b64_tr_b16 v[66:67], v28 offset:35328
    ds_read_b64_tr_b16 v[68:69], v29 offset:34816
    v_mfma_f32_32x32x16_bf16 v[224:239], v[120:123], v[108:111], v[224:239]
    ds_read_b64_tr_b16 v[70:71], v29 offset:35328
    ds_read_b64_tr_b16 v[72:73], v30 offset:34816
    ds_read_b64_tr_b16 v[74:75], v30 offset:35328
    v_mfma_f32_32x32x16_bf16 v[240:255], v[124:127], v[108:111], v[240:255]
    ds_read_b64_tr_b16 v[76:77], v31 offset:34816
    ds_read_b64_tr_b16 v[78:79], v31 offset:35328
    s_waitcnt lgkmcnt(10)
    v_mfma_f32_32x32x16_bf16 v[128:143], v[40:43], v[32:35], v[128:143]
    ds_read_b128 v[80:83], v26 offset:32768
    s_mov_b32 m0, s40
    s_nop 0
    buffer_load_dwordx4 v16, s[4:7], s34 offen offset:0 lds
    ds_read_b128 v[84:87], v26 offset:36864
    v_mfma_f32_32x32x16_bf16 v[144:159], v[44:47], v[32:35], v[144:159]
    buffer_load_dwordx4 v17, s[4:7], s34 offen offset:1024 lds
    ds_read_b64_tr_b16 v[88:89], v28 offset:36864
    v_mfma_f32_32x32x16_bf16 v[160:175], v[48:51], v[32:35], v[160:175]
    buffer_load_dwordx4 v18, s[4:7], s34 offen offset:2048 lds
    ds_read_b64_tr_b16 v[90:91], v28 offset:37376
    v_mfma_f32_32x32x16_bf16 v[176:191], v[52:55], v[32:35], v[176:191]
    buffer_load_dwordx4 v19, s[4:7], s34 offen offset:3072 lds
    ds_read_b64_tr_b16 v[92:93], v29 offset:36864
    v_mfma_f32_32x32x16_bf16 v[192:207], v[40:43], v[36:39], v[192:207]
    ds_read_b64_tr_b16 v[94:95], v29 offset:37376
    s_mov_b32 m0, s48
    s_nop 0
    buffer_load_dwordx4 v20, s[8:11], s35 offen offset:0 lds
    ds_read_b64_tr_b16 v[96:97], v30 offset:36864
    v_mfma_f32_32x32x16_bf16 v[208:223], v[44:47], v[36:39], v[208:223]
    buffer_load_dwordx4 v21, s[8:11], s35 offen offset:1024 lds
    ds_read_b64_tr_b16 v[98:99], v30 offset:37376
    v_mfma_f32_32x32x16_bf16 v[224:239], v[48:51], v[36:39], v[224:239]
    buffer_load_dwordx4 v22, s[8:11], s35 offen offset:2048 lds
    ds_read_b64_tr_b16 v[100:101], v31 offset:36864
    v_mfma_f32_32x32x16_bf16 v[240:255], v[52:55], v[36:39], v[240:255]
    buffer_load_dwordx4 v23, s[8:11], s35 offen offset:3072 lds
    ds_read_b64_tr_b16 v[102:103], v31 offset:37376
    s_waitcnt lgkmcnt(10)
    v_mfma_f32_32x32x16_bf16 v[128:143], v[64:67], v[56:59], v[128:143]
    ds_read_b128 v[104:107], v27 offset:32768
    ds_read_b128 v[108:111], v27 offset:36864
    v_mfma_f32_32x32x16_bf16 v[144:159], v[68:71], v[56:59], v[144:159]
    ds_read_b64_tr_b16 v[112:113], v28 offset:38912
    v_mfma_f32_32x32x16_bf16 v[160:175], v[72:75], v[56:59], v[160:175]
    ds_read_b64_tr_b16 v[114:115], v28 offset:39424
    v_mfma_f32_32x32x16_bf16 v[176:191], v[76:79], v[56:59], v[176:191]
    ds_read_b64_tr_b16 v[116:117], v29 offset:38912
    v_mfma_f32_32x32x16_bf16 v[192:207], v[64:67], v[60:63], v[192:207]
    ds_read_b64_tr_b16 v[118:119], v29 offset:39424
    ds_read_b64_tr_b16 v[120:121], v30 offset:38912
    v_mfma_f32_32x32x16_bf16 v[208:223], v[68:71], v[60:63], v[208:223]
    ds_read_b64_tr_b16 v[122:123], v30 offset:39424
    v_mfma_f32_32x32x16_bf16 v[224:239], v[72:75], v[60:63], v[224:239]
    ds_read_b64_tr_b16 v[124:125], v31 offset:38912
    v_mfma_f32_32x32x16_bf16 v[240:255], v[76:79], v[60:63], v[240:255]
    ds_read_b64_tr_b16 v[126:127], v31 offset:39424
    s_waitcnt lgkmcnt(10)
    v_mfma_f32_32x32x16_bf16 v[128:143], v[88:91], v[80:83], v[128:143]
    v_mfma_f32_32x32x16_bf16 v[144:159], v[92:95], v[80:83], v[144:159]
    v_mfma_f32_32x32x16_bf16 v[160:175], v[96:99], v[80:83], v[160:175]
    v_mfma_f32_32x32x16_bf16 v[176:191], v[100:103], v[80:83], v[176:191]
    v_mfma_f32_32x32x16_bf16 v[192:207], v[88:91], v[84:87], v[192:207]
    v_mfma_f32_32x32x16_bf16 v[208:223], v[92:95], v[84:87], v[208:223]
    v_mfma_f32_32x32x16_bf16 v[224:239], v[96:99], v[84:87], v[224:239]
    v_mfma_f32_32x32x16_bf16 v[240:255], v[100:103], v[84:87], v[240:255]
    s_add_u32 s34, s34, 128
    s_add_u32 s35, s35, 0x70000
    s_waitcnt lgkmcnt(0)
    s_waitcnt vmcnt(0) lgkmcnt(0)
    s_barrier
    v_mfma_f32_32x32x16_bf16 v[128:143], v[112:115], v[104:107], v[128:143]
    ds_read_b128 v[32:35], v24 offset:0
    ds_read_b128 v[36:39], v24 offset:4096
    ds_read_b64_tr_b16 v[40:41], v28 offset:0
    v_mfma_f32_32x32x16_bf16 v[144:159], v[116:119], v[104:107], v[144:159]
    ds_read_b64_tr_b16 v[42:43], v28 offset:512
    ds_read_b64_tr_b16 v[44:45], v29 offset:0
    v_mfma_f32_32x32x16_bf16 v[160:175], v[120:123], v[104:107], v[160:175]
    ds_read_b64_tr_b16 v[46:47], v29 offset:512
    ds_read_b64_tr_b16 v[48:49], v30 offset:0
    ds_read_b64_tr_b16 v[50:51], v30 offset:512
    v_mfma_f32_32x32x16_bf16 v[176:191], v[124:127], v[104:107], v[176:191]
    ds_read_b64_tr_b16 v[52:53], v31 offset:0
    ds_read_b64_tr_b16 v[54:55], v31 offset:512
    v_mfma_f32_32x32x16_bf16 v[192:207], v[112:115], v[108:111], v[192:207]
    ds_read_b128 v[56:59], v25 offset:0
    ds_read_b128 v[60:63], v25 offset:4096
    ds_read_b64_tr_b16 v[64:65], v28 offset:2048
    v_mfma_f32_32x32x16_bf16 v[208:223], v[116:119], v[108:111], v[208:223]
    ds_read_b64_tr_b16 v[66:67], v28 offset:2560
    ds_read_b64_tr_b16 v[68:69], v29 offset:2048
    v_mfma_f32_32x32x16_bf16 v[224:239], v[120:123], v[108:111], v[224:239]
    ds_read_b64_tr_b16 v[70:71], v29 offset:2560
    ds_read_b64_tr_b16 v[72:73], v30 offset:2048
    ds_read_b64_tr_b16 v[74:75], v30 offset:2560
    v_mfma_f32_32x32x16_bf16 v[240:255], v[124:127], v[108:111], v[240:255]
    ds_read_b64_tr_b16 v[76:77], v31 offset:2048
    ds_read_b64_tr_b16 v[78:79], v31 offset:2560
    s_sub_u32 s36, s36, 1
    s_cmp_lg_u32 s36, 0
    s_cbranch_scc1 il_g3_kernel_loop_2
    s_waitcnt lgkmcnt(10)
    v_mfma_f32_32x32x16_bf16 v[128:143], v[40:43], v[32:35], v[128:143]
    ds_read_b128 v[80:83], v26 offset:0
    s_mov_b32 m0, s41
    s_nop 0
    buffer_load_dwordx4 v16, s[4:7], s34 offen offset:0 lds
    ds_read_b128 v[84:87], v26 offset:4096
    v_mfma_f32_32x32x16_bf16 v[144:159], v[44:47], v[32:35], v[144:159]
    buffer_load_dwordx4 v17, s[4:7], s34 offen offset:1024 lds
    ds_read_b64_tr_b16 v[88:89], v28 offset:4096
    v_mfma_f32_32x32x16_bf16 v[160:175], v[48:51], v[32:35], v[160:175]
    buffer_load_dwordx4 v18, s[4:7], s34 offen offset:2048 lds
    ds_read_b64_tr_b16 v[90:91], v28 offset:4608
    v_mfma_f32_32x32x16_bf16 v[176:191], v[52:55], v[32:35], v[176:191]
    buffer_load_dwordx4 v19, s[4:7], s34 offen offset:3072 lds
    ds_read_b64_tr_b16 v[92:93], v29 offset:4096
    v_mfma_f32_32x32x16_bf16 v[192:207], v[40:43], v[36:39], v[192:207]
    ds_read_b64_tr_b16 v[94:95], v29 offset:4608
    s_mov_b32 m0, s49
    s_nop 0
    buffer_load_dwordx4 v20, s[8:11], s35 offen offset:0 lds
    ds_read_b64_tr_b16 v[96:97], v30 offset:4096
    v_mfma_f32_32x32x16_bf16 v[208:223], v[44:47], v[36:39], v[208:223]
    buffer_load_dwordx4 v21, s[8:11], s35 offen offset:1024 lds
    ds_read_b64_tr_b16 v[98:99], v30 offset:4608
    v_mfma_f32_32x32x16_bf16 v[224:239], v[48:51], v[36:39], v[224:239]
    buffer_load_dwordx4 v22, s[8:11], s35 offen offset:2048 lds
    ds_read_b64_tr_b16 v[100:101], v31 offset:4096
    v_mfma_f32_32x32x16_bf16 v[240:255], v[52:55], v[36:39], v[240:255]
    buffer_load_dwordx4 v23, s[8:11], s35 offen offset:3072 lds
    ds_read_b64_tr_b16 v[102:103], v31 offset:4608
    s_waitcnt lgkmcnt(10)
    v_mfma_f32_32x32x16_bf16 v[128:143], v[64:67], v[56:59], v[128:143]
    ds_read_b128 v[104:107], v27 offset:0
    ds_read_b128 v[108:111], v27 offset:4096
    v_mfma_f32_32x32x16_bf16 v[144:159], v[68:71], v[56:59], v[144:159]
    ds_read_b64_tr_b16 v[112:113], v28 offset:6144
    v_mfma_f32_32x32x16_bf16 v[160:175], v[72:75], v[56:59], v[160:175]
    ds_read_b64_tr_b16 v[114:115], v28 offset:6656
    v_mfma_f32_32x32x16_bf16 v[176:191], v[76:79], v[56:59], v[176:191]
    ds_read_b64_tr_b16 v[116:117], v29 offset:6144
    v_mfma_f32_32x32x16_bf16 v[192:207], v[64:67], v[60:63], v[192:207]
    ds_read_b64_tr_b16 v[118:119], v29 offset:6656
    ds_read_b64_tr_b16 v[120:121], v30 offset:6144
    v_mfma_f32_32x32x16_bf16 v[208:223], v[68:71], v[60:63], v[208:223]
    ds_read_b64_tr_b16 v[122:123], v30 offset:6656
    v_mfma_f32_32x32x16_bf16 v[224:239], v[72:75], v[60:63], v[224:239]
    ds_read_b64_tr_b16 v[124:125], v31 offset:6144
    v_mfma_f32_32x32x16_bf16 v[240:255], v[76:79], v[60:63], v[240:255]
    ds_read_b64_tr_b16 v[126:127], v31 offset:6656
    s_waitcnt lgkmcnt(10)
    v_mfma_f32_32x32x16_bf16 v[128:143], v[88:91], v[80:83], v[128:143]
    v_mfma_f32_32x32x16_bf16 v[144:159], v[92:95], v[80:83], v[144:159]
    v_mfma_f32_32x32x16_bf16 v[160:175], v[96:99], v[80:83], v[160:175]
    v_mfma_f32_32x32x16_bf16 v[176:191], v[100:103], v[80:83], v[176:191]
    v_mfma_f32_32x32x16_bf16 v[192:207], v[88:91], v[84:87], v[192:207]
    v_mfma_f32_32x32x16_bf16 v[208:223], v[92:95], v[84:87], v[208:223]
    v_mfma_f32_32x32x16_bf16 v[224:239], v[96:99], v[84:87], v[224:239]
    v_mfma_f32_32x32x16_bf16 v[240:255], v[100:103], v[84:87], v[240:255]
    s_add_u32 s34, s34, 128
    s_add_u32 s35, s35, 0x70000
    s_waitcnt lgkmcnt(0)
    s_waitcnt vmcnt(0) lgkmcnt(0)
    s_barrier
    v_mfma_f32_32x32x16_bf16 v[128:143], v[112:115], v[104:107], v[128:143]
    ds_read_b128 v[32:35], v24 offset:32768
    ds_read_b128 v[36:39], v24 offset:36864
    ds_read_b64_tr_b16 v[40:41], v28 offset:32768
    v_mfma_f32_32x32x16_bf16 v[144:159], v[116:119], v[104:107], v[144:159]
    ds_read_b64_tr_b16 v[42:43], v28 offset:33280
    ds_read_b64_tr_b16 v[44:45], v29 offset:32768
    v_mfma_f32_32x32x16_bf16 v[160:175], v[120:123], v[104:107], v[160:175]
    ds_read_b64_tr_b16 v[46:47], v29 offset:33280
    ds_read_b64_tr_b16 v[48:49], v30 offset:32768
    ds_read_b64_tr_b16 v[50:51], v30 offset:33280
    v_mfma_f32_32x32x16_bf16 v[176:191], v[124:127], v[104:107], v[176:191]
    ds_read_b64_tr_b16 v[52:53], v31 offset:32768
    ds_read_b64_tr_b16 v[54:55], v31 offset:33280
    v_mfma_f32_32x32x16_bf16 v[192:207], v[112:115], v[108:111], v[192:207]
    ds_read_b128 v[56:59], v25 offset:32768
    ds_read_b128 v[60:63], v25 offset:36864
    ds_read_b64_tr_b16 v[64:65], v28 offset:34816
    v_mfma_f32_32x32x16_bf16 v[208:223], v[116:119], v[108:111], v[208:223]
    ds_read_b64_tr_b16 v[66:67], v28 offset:35328
    ds_read_b64_tr_b16 v[68:69], v29 offset:34816
    v_mfma_f32_32x32x16_bf16 v[224:239], v[120:123], v[108:111], v[224:239]
    ds_read_b64_tr_b16 v[70:71], v29 offset:35328
    ds_read_b64_tr_b16 v[72:73], v30 offset:34816
    ds_read_b64_tr_b16 v[74:75], v30 offset:35328
    v_mfma_f32_32x32x16_bf16 v[240:255], v[124:127], v[108:111], v[240:255]
    ds_read_b64_tr_b16 v[76:77], v31 offset:34816
    ds_read_b64_tr_b16 v[78:79], v31 offset:35328
    s_waitcnt lgkmcnt(10)
    v_mfma_f32_32x32x16_bf16 v[128:143], v[40:43], v[32:35], v[128:143]
    ds_read_b128 v[80:83], v26 offset:32768
    ds_read_b128 v[84:87], v26 offset:36864
    v_mfma_f32_32x32x16_bf16 v[144:159], v[44:47], v[32:35], v[144:159]
    ds_read_b64_tr_b16 v[88:89], v28 offset:36864
    v_mfma_f32_32x32x16_bf16 v[160:175], v[48:51], v[32:35], v[160:175]
    ds_read_b64_tr_b16 v[90:91], v28 offset:37376
    v_mfma_f32_32x32x16_bf16 v[176:191], v[52:55], v[32:35], v[176:191]
    ds_read_b64_tr_b16 v[92:93], v29 offset:36864
    v_mfma_f32_32x32x16_bf16 v[192:207], v[40:43], v[36:39], v[192:207]
    ds_read_b64_tr_b16 v[94:95], v29 offset:37376
    ds_read_b64_tr_b16 v[96:97], v30 offset:36864
    v_mfma_f32_32x32x16_bf16 v[208:223], v[44:47], v[36:39], v[208:223]
    ds_read_b64_tr_b16 v[98:99], v30 offset:37376
    v_mfma_f32_32x32x16_bf16 v[224:239], v[48:51], v[36:39], v[224:239]
    ds_read_b64_tr_b16 v[100:101], v31 offset:36864
    v_mfma_f32_32x32x16_bf16 v[240:255], v[52:55], v[36:39], v[240:255]
    ds_read_b64_tr_b16 v[102:103], v31 offset:37376
    s_waitcnt lgkmcnt(10)
    v_mfma_f32_32x32x16_bf16 v[128:143], v[64:67], v[56:59], v[128:143]
    ds_read_b128 v[104:107], v27 offset:32768
    ds_read_b128 v[108:111], v27 offset:36864
    v_mfma_f32_32x32x16_bf16 v[144:159], v[68:71], v[56:59], v[144:159]
    ds_read_b64_tr_b16 v[112:113], v28 offset:38912
    v_mfma_f32_32x32x16_bf16 v[160:175], v[72:75], v[56:59], v[160:175]
    ds_read_b64_tr_b16 v[114:115], v28 offset:39424
    v_mfma_f32_32x32x16_bf16 v[176:191], v[76:79], v[56:59], v[176:191]
    ds_read_b64_tr_b16 v[116:117], v29 offset:38912
    v_mfma_f32_32x32x16_bf16 v[192:207], v[64:67], v[60:63], v[192:207]
    ds_read_b64_tr_b16 v[118:119], v29 offset:39424
    ds_read_b64_tr_b16 v[120:121], v30 offset:38912
    v_mfma_f32_32x32x16_bf16 v[208:223], v[68:71], v[60:63], v[208:223]
    ds_read_b64_tr_b16 v[122:123], v30 offset:39424
    v_mfma_f32_32x32x16_bf16 v[224:239], v[72:75], v[60:63], v[224:239]
    ds_read_b64_tr_b16 v[124:125], v31 offset:38912
    v_mfma_f32_32x32x16_bf16 v[240:255], v[76:79], v[60:63], v[240:255]
    ds_read_b64_tr_b16 v[126:127], v31 offset:39424
    s_waitcnt lgkmcnt(10)
    v_mfma_f32_32x32x16_bf16 v[128:143], v[88:91], v[80:83], v[128:143]
    v_mfma_f32_32x32x16_bf16 v[144:159], v[92:95], v[80:83], v[144:159]
    v_mfma_f32_32x32x16_bf16 v[160:175], v[96:99], v[80:83], v[160:175]
    v_mfma_f32_32x32x16_bf16 v[176:191], v[100:103], v[80:83], v[176:191]
    v_mfma_f32_32x32x16_bf16 v[192:207], v[88:91], v[84:87], v[192:207]
    v_mfma_f32_32x32x16_bf16 v[208:223], v[92:95], v[84:87], v[208:223]
    v_mfma_f32_32x32x16_bf16 v[224:239], v[96:99], v[84:87], v[224:239]
    v_mfma_f32_32x32x16_bf16 v[240:255], v[100:103], v[84:87], v[240:255]
    s_waitcnt lgkmcnt(0)
    v_mfma_f32_32x32x16_bf16 v[128:143], v[112:115], v[104:107], v[128:143]
    v_mfma_f32_32x32x16_bf16 v[144:159], v[116:119], v[104:107], v[144:159]
    v_mfma_f32_32x32x16_bf16 v[160:175], v[120:123], v[104:107], v[160:175]
    v_mfma_f32_32x32x16_bf16 v[176:191], v[124:127], v[104:107], v[176:191]
    v_mfma_f32_32x32x16_bf16 v[192:207], v[112:115], v[108:111], v[192:207]
    v_mfma_f32_32x32x16_bf16 v[208:223], v[116:119], v[108:111], v[208:223]
    v_mfma_f32_32x32x16_bf16 v[224:239], v[120:123], v[108:111], v[224:239]
    v_mfma_f32_32x32x16_bf16 v[240:255], v[124:127], v[108:111], v[240:255]
    s_nop 15
    s_nop 3
    s_barrier
    s_mul_i32 s23, s20, 8192
    v_and_b32 v10, 7, v8
    v_lshlrev_b32 v10, 4, v10
    v_lshl_add_u32 v10, v9, 3, v10
    v_mul_u32_u24 v13, 128, v8
    v_add_u32 v10, v10, v13
    v_add_u32 v10, s23, v10
    v_lshrrev_b32 v13, 3, v2
    v_and_b32 v14, 7, v2
    v_and_b32 v15, 7, v13
    v_xor_b32 v15, v15, v14
    v_lshlrev_b32 v15, 4, v15
    v_mul_u32_u24 v11, 128, v13
    v_add_u32 v11, v11, v15
    v_add_u32 v11, s23, v11
    s_mul_i32 s23, s21, 64
    v_add_u32 v13, s23, v13
    v_mul_u32_u24 v12, 0x1c00, v13
    v_lshl_add_u32 v12, v14, 4, v12
    s_mul_i32 s23, s22, 128
    v_add_u32 v12, s23, v12
    s_mov_b32 s23, 0xbfb8aa3b
    v_cvt_pk_bf16_f32 v32, v128, v160
    v_cvt_pk_bf16_f32 v33, v129, v161
    v_cvt_pk_bf16_f32 v34, v130, v162
    v_cvt_pk_bf16_f32 v35, v131, v163
    v_lshlrev_b32 v36, 16, v32
    v_lshlrev_b32 v37, 16, v33
    v_lshlrev_b32 v38, 16, v34
    v_lshlrev_b32 v39, 16, v35
    v_mul_f32 v36, s23, v36
    v_mul_f32 v37, s23, v37
    v_mul_f32 v38, s23, v38
    v_mul_f32 v39, s23, v39
    v_exp_f32 v36, v36
    v_exp_f32 v37, v37
    v_exp_f32 v38, v38
    v_exp_f32 v39, v39
    v_add_f32 v36, 1.0, v36
    v_add_f32 v37, 1.0, v37
    v_add_f32 v38, 1.0, v38
    v_add_f32 v39, 1.0, v39
    v_rcp_f32 v36, v36
    v_rcp_f32 v37, v37
    v_rcp_f32 v38, v38
    v_rcp_f32 v39, v39
    v_and_b32 v32, 0xffff0000, v32
    v_and_b32 v33, 0xffff0000, v33
    v_and_b32 v34, 0xffff0000, v34
    v_and_b32 v35, 0xffff0000, v35
    v_cvt_pk_bf16_f32 v36, v36, v37
    v_cvt_pk_bf16_f32 v38, v38, v39
    v_and_b32 v37, 0xffff0000, v36
    v_lshlrev_b32 v36, 16, v36
    v_and_b32 v39, 0xffff0000, v38
    v_lshlrev_b32 v38, 16, v38
    v_mul_f32 v32, v36, v32
    v_mul_f32 v33, v37, v33
    v_mul_f32 v34, v38, v34
    v_mul_f32 v35, v39, v35
    v_cvt_pk_bf16_f32 v128, v32, v33
    v_cvt_pk_bf16_f32 v129, v34, v35
    ds_write_b64 v10, v[128:129] offset:0
    v_cvt_pk_bf16_f32 v40, v132, v164
    v_cvt_pk_bf16_f32 v41, v133, v165
    v_cvt_pk_bf16_f32 v42, v134, v166
    v_cvt_pk_bf16_f32 v43, v135, v167
    v_lshlrev_b32 v44, 16, v40
    v_lshlrev_b32 v45, 16, v41
    v_lshlrev_b32 v46, 16, v42
    v_lshlrev_b32 v47, 16, v43
    v_mul_f32 v44, s23, v44
    v_mul_f32 v45, s23, v45
    v_mul_f32 v46, s23, v46
    v_mul_f32 v47, s23, v47
    v_exp_f32 v44, v44
    v_exp_f32 v45, v45
    v_exp_f32 v46, v46
    v_exp_f32 v47, v47
    v_add_f32 v44, 1.0, v44
    v_add_f32 v45, 1.0, v45
    v_add_f32 v46, 1.0, v46
    v_add_f32 v47, 1.0, v47
    v_rcp_f32 v44, v44
    v_rcp_f32 v45, v45
    v_rcp_f32 v46, v46
    v_rcp_f32 v47, v47
    v_and_b32 v40, 0xffff0000, v40
    v_and_b32 v41, 0xffff0000, v41
    v_and_b32 v42, 0xffff0000, v42
    v_and_b32 v43, 0xffff0000, v43
    v_cvt_pk_bf16_f32 v44, v44, v45
    v_cvt_pk_bf16_f32 v46, v46, v47
    v_and_b32 v45, 0xffff0000, v44
    v_lshlrev_b32 v44, 16, v44
    v_and_b32 v47, 0xffff0000, v46
    v_lshlrev_b32 v46, 16, v46
    v_mul_f32 v40, v44, v40
    v_mul_f32 v41, v45, v41
    v_mul_f32 v42, v46, v42
    v_mul_f32 v43, v47, v43
    v_cvt_pk_bf16_f32 v132, v40, v41
    v_cvt_pk_bf16_f32 v133, v42, v43
    v_xor_b32 v13, 0x10, v10
    ds_write_b64 v13, v[132:133] offset:0
    v_cvt_pk_bf16_f32 v32, v136, v168
    v_cvt_pk_bf16_f32 v33, v137, v169
    v_cvt_pk_bf16_f32 v34, v138, v170
    v_cvt_pk_bf16_f32 v35, v139, v171
    v_lshlrev_b32 v36, 16, v32
    v_lshlrev_b32 v37, 16, v33
    v_lshlrev_b32 v38, 16, v34
    v_lshlrev_b32 v39, 16, v35
    v_mul_f32 v36, s23, v36
    v_mul_f32 v37, s23, v37
    v_mul_f32 v38, s23, v38
    v_mul_f32 v39, s23, v39
    v_exp_f32 v36, v36
    v_exp_f32 v37, v37
    v_exp_f32 v38, v38
    v_exp_f32 v39, v39
    v_add_f32 v36, 1.0, v36
    v_add_f32 v37, 1.0, v37
    v_add_f32 v38, 1.0, v38
    v_add_f32 v39, 1.0, v39
    v_rcp_f32 v36, v36
    v_rcp_f32 v37, v37
    v_rcp_f32 v38, v38
    v_rcp_f32 v39, v39
    v_and_b32 v32, 0xffff0000, v32
    v_and_b32 v33, 0xffff0000, v33
    v_and_b32 v34, 0xffff0000, v34
    v_and_b32 v35, 0xffff0000, v35
    v_cvt_pk_bf16_f32 v36, v36, v37
    v_cvt_pk_bf16_f32 v38, v38, v39
    v_and_b32 v37, 0xffff0000, v36
    v_lshlrev_b32 v36, 16, v36
    v_and_b32 v39, 0xffff0000, v38
    v_lshlrev_b32 v38, 16, v38
    v_mul_f32 v32, v36, v32
    v_mul_f32 v33, v37, v33
    v_mul_f32 v34, v38, v34
    v_mul_f32 v35, v39, v35
    v_cvt_pk_bf16_f32 v136, v32, v33
    v_cvt_pk_bf16_f32 v137, v34, v35
    v_xor_b32 v13, 0x20, v10
    ds_write_b64 v13, v[136:137] offset:0
    v_cvt_pk_bf16_f32 v40, v140, v172
    v_cvt_pk_bf16_f32 v41, v141, v173
    v_cvt_pk_bf16_f32 v42, v142, v174
    v_cvt_pk_bf16_f32 v43, v143, v175
    v_lshlrev_b32 v44, 16, v40
    v_lshlrev_b32 v45, 16, v41
    v_lshlrev_b32 v46, 16, v42
    v_lshlrev_b32 v47, 16, v43
    v_mul_f32 v44, s23, v44
    v_mul_f32 v45, s23, v45
    v_mul_f32 v46, s23, v46
    v_mul_f32 v47, s23, v47
    v_exp_f32 v44, v44
    v_exp_f32 v45, v45
    v_exp_f32 v46, v46
    v_exp_f32 v47, v47
    v_add_f32 v44, 1.0, v44
    v_add_f32 v45, 1.0, v45
    v_add_f32 v46, 1.0, v46
    v_add_f32 v47, 1.0, v47
    v_rcp_f32 v44, v44
    v_rcp_f32 v45, v45
    v_rcp_f32 v46, v46
    v_rcp_f32 v47, v47
    v_and_b32 v40, 0xffff0000, v40
    v_and_b32 v41, 0xffff0000, v41
    v_and_b32 v42, 0xffff0000, v42
    v_and_b32 v43, 0xffff0000, v43
    v_cvt_pk_bf16_f32 v44, v44, v45
    v_cvt_pk_bf16_f32 v46, v46, v47
    v_and_b32 v45, 0xffff0000, v44
    v_lshlrev_b32 v44, 16, v44
    v_and_b32 v47, 0xffff0000, v46
    v_lshlrev_b32 v46, 16, v46
    v_mul_f32 v40, v44, v40
    v_mul_f32 v41, v45, v41
    v_mul_f32 v42, v46, v42
    v_mul_f32 v43, v47, v43
    v_cvt_pk_bf16_f32 v140, v40, v41
    v_cvt_pk_bf16_f32 v141, v42, v43
    v_xor_b32 v13, 0x30, v10
    ds_write_b64 v13, v[140:141] offset:0
    v_cvt_pk_bf16_f32 v32, v144, v176
    v_cvt_pk_bf16_f32 v33, v145, v177
    v_cvt_pk_bf16_f32 v34, v146, v178
    v_cvt_pk_bf16_f32 v35, v147, v179
    v_lshlrev_b32 v36, 16, v32
    v_lshlrev_b32 v37, 16, v33
    v_lshlrev_b32 v38, 16, v34
    v_lshlrev_b32 v39, 16, v35
    v_mul_f32 v36, s23, v36
    v_mul_f32 v37, s23, v37
    v_mul_f32 v38, s23, v38
    v_mul_f32 v39, s23, v39
    v_exp_f32 v36, v36
    v_exp_f32 v37, v37
    v_exp_f32 v38, v38
    v_exp_f32 v39, v39
    v_add_f32 v36, 1.0, v36
    v_add_f32 v37, 1.0, v37
    v_add_f32 v38, 1.0, v38
    v_add_f32 v39, 1.0, v39
    v_rcp_f32 v36, v36
    v_rcp_f32 v37, v37
    v_rcp_f32 v38, v38
    v_rcp_f32 v39, v39
    v_and_b32 v32, 0xffff0000, v32
    v_and_b32 v33, 0xffff0000, v33
    v_and_b32 v34, 0xffff0000, v34
    v_and_b32 v35, 0xffff0000, v35
    v_cvt_pk_bf16_f32 v36, v36, v37
    v_cvt_pk_bf16_f32 v38, v38, v39
    v_and_b32 v37, 0xffff0000, v36
    v_lshlrev_b32 v36, 16, v36
    v_and_b32 v39, 0xffff0000, v38
    v_lshlrev_b32 v38, 16, v38
    v_mul_f32 v32, v36, v32
    v_mul_f32 v33, v37, v33
    v_mul_f32 v34, v38, v34
    v_mul_f32 v35, v39, v35
    v_cvt_pk_bf16_f32 v144, v32, v33
    v_cvt_pk_bf16_f32 v145, v34, v35
    v_xor_b32 v13, 0x40, v10
    ds_write_b64 v13, v[144:145] offset:0
    v_cvt_pk_bf16_f32 v40, v148, v180
    v_cvt_pk_bf16_f32 v41, v149, v181
    v_cvt_pk_bf16_f32 v42, v150, v182
    v_cvt_pk_bf16_f32 v43, v151, v183
    v_lshlrev_b32 v44, 16, v40
    v_lshlrev_b32 v45, 16, v41
    v_lshlrev_b32 v46, 16, v42
    v_lshlrev_b32 v47, 16, v43
    v_mul_f32 v44, s23, v44
    v_mul_f32 v45, s23, v45
    v_mul_f32 v46, s23, v46
    v_mul_f32 v47, s23, v47
    v_exp_f32 v44, v44
    v_exp_f32 v45, v45
    v_exp_f32 v46, v46
    v_exp_f32 v47, v47
    v_add_f32 v44, 1.0, v44
    v_add_f32 v45, 1.0, v45
    v_add_f32 v46, 1.0, v46
    v_add_f32 v47, 1.0, v47
    v_rcp_f32 v44, v44
    v_rcp_f32 v45, v45
    v_rcp_f32 v46, v46
    v_rcp_f32 v47, v47
    v_and_b32 v40, 0xffff0000, v40
    v_and_b32 v41, 0xffff0000, v41
    v_and_b32 v42, 0xffff0000, v42
    v_and_b32 v43, 0xffff0000, v43
    v_cvt_pk_bf16_f32 v44, v44, v45
    v_cvt_pk_bf16_f32 v46, v46, v47
    v_and_b32 v45, 0xffff0000, v44
    v_lshlrev_b32 v44, 16, v44
    v_and_b32 v47, 0xffff0000, v46
    v_lshlrev_b32 v46, 16, v46
    v_mul_f32 v40, v44, v40
    v_mul_f32 v41, v45, v41
    v_mul_f32 v42, v46, v42
    v_mul_f32 v43, v47, v43
    v_cvt_pk_bf16_f32 v148, v40, v41
    v_cvt_pk_bf16_f32 v149, v42, v43
    v_xor_b32 v13, 0x50, v10
    ds_write_b64 v13, v[148:149] offset:0
    v_cvt_pk_bf16_f32 v32, v152, v184
    v_cvt_pk_bf16_f32 v33, v153, v185
    v_cvt_pk_bf16_f32 v34, v154, v186
    v_cvt_pk_bf16_f32 v35, v155, v187
    v_lshlrev_b32 v36, 16, v32
    v_lshlrev_b32 v37, 16, v33
    v_lshlrev_b32 v38, 16, v34
    v_lshlrev_b32 v39, 16, v35
    v_mul_f32 v36, s23, v36
    v_mul_f32 v37, s23, v37
    v_mul_f32 v38, s23, v38
    v_mul_f32 v39, s23, v39
    v_exp_f32 v36, v36
    v_exp_f32 v37, v37
    v_exp_f32 v38, v38
    v_exp_f32 v39, v39
    v_add_f32 v36, 1.0, v36
    v_add_f32 v37, 1.0, v37
    v_add_f32 v38, 1.0, v38
    v_add_f32 v39, 1.0, v39
    v_rcp_f32 v36, v36
    v_rcp_f32 v37, v37
    v_rcp_f32 v38, v38
    v_rcp_f32 v39, v39
    v_and_b32 v32, 0xffff0000, v32
    v_and_b32 v33, 0xffff0000, v33
    v_and_b32 v34, 0xffff0000, v34
    v_and_b32 v35, 0xffff0000, v35
    v_cvt_pk_bf16_f32 v36, v36, v37
    v_cvt_pk_bf16_f32 v38, v38, v39
    v_and_b32 v37, 0xffff0000, v36
    v_lshlrev_b32 v36, 16, v36
    v_and_b32 v39, 0xffff0000, v38
    v_lshlrev_b32 v38, 16, v38
    v_mul_f32 v32, v36, v32
    v_mul_f32 v33, v37, v33
    v_mul_f32 v34, v38, v34
    v_mul_f32 v35, v39, v35
    v_cvt_pk_bf16_f32 v152, v32, v33
    v_cvt_pk_bf16_f32 v153, v34, v35
    v_xor_b32 v13, 0x60, v10
    ds_write_b64 v13, v[152:153] offset:0
    v_cvt_pk_bf16_f32 v40, v156, v188
    v_cvt_pk_bf16_f32 v41, v157, v189
    v_cvt_pk_bf16_f32 v42, v158, v190
    v_cvt_pk_bf16_f32 v43, v159, v191
    v_lshlrev_b32 v44, 16, v40
    v_lshlrev_b32 v45, 16, v41
    v_lshlrev_b32 v46, 16, v42
    v_lshlrev_b32 v47, 16, v43
    v_mul_f32 v44, s23, v44
    v_mul_f32 v45, s23, v45
    v_mul_f32 v46, s23, v46
    v_mul_f32 v47, s23, v47
    v_exp_f32 v44, v44
    v_exp_f32 v45, v45
    v_exp_f32 v46, v46
    v_exp_f32 v47, v47
    v_add_f32 v44, 1.0, v44
    v_add_f32 v45, 1.0, v45
    v_add_f32 v46, 1.0, v46
    v_add_f32 v47, 1.0, v47
    v_rcp_f32 v44, v44
    v_rcp_f32 v45, v45
    v_rcp_f32 v46, v46
    v_rcp_f32 v47, v47
    v_and_b32 v40, 0xffff0000, v40
    v_and_b32 v41, 0xffff0000, v41
    v_and_b32 v42, 0xffff0000, v42
    v_and_b32 v43, 0xffff0000, v43
    v_cvt_pk_bf16_f32 v44, v44, v45
    v_cvt_pk_bf16_f32 v46, v46, v47
    v_and_b32 v45, 0xffff0000, v44
    v_lshlrev_b32 v44, 16, v44
    v_and_b32 v47, 0xffff0000, v46
    v_lshlrev_b32 v46, 16, v46
    v_mul_f32 v40, v44, v40
    v_mul_f32 v41, v45, v41
    v_mul_f32 v42, v46, v42
    v_mul_f32 v43, v47, v43
    v_cvt_pk_bf16_f32 v156, v40, v41
    v_cvt_pk_bf16_f32 v157, v42, v43
    v_xor_b32 v13, 0x70, v10
    ds_write_b64 v13, v[156:157] offset:0
    v_cvt_pk_bf16_f32 v32, v192, v224
    v_cvt_pk_bf16_f32 v33, v193, v225
    v_cvt_pk_bf16_f32 v34, v194, v226
    v_cvt_pk_bf16_f32 v35, v195, v227
    v_lshlrev_b32 v36, 16, v32
    v_lshlrev_b32 v37, 16, v33
    v_lshlrev_b32 v38, 16, v34
    v_lshlrev_b32 v39, 16, v35
    v_mul_f32 v36, s23, v36
    v_mul_f32 v37, s23, v37
    v_mul_f32 v38, s23, v38
    v_mul_f32 v39, s23, v39
    v_exp_f32 v36, v36
    v_exp_f32 v37, v37
    v_exp_f32 v38, v38
    v_exp_f32 v39, v39
    v_add_f32 v36, 1.0, v36
    v_add_f32 v37, 1.0, v37
    v_add_f32 v38, 1.0, v38
    v_add_f32 v39, 1.0, v39
    v_rcp_f32 v36, v36
    v_rcp_f32 v37, v37
    v_rcp_f32 v38, v38
    v_rcp_f32 v39, v39
    v_and_b32 v32, 0xffff0000, v32
    v_and_b32 v33, 0xffff0000, v33
    v_and_b32 v34, 0xffff0000, v34
    v_and_b32 v35, 0xffff0000, v35
    v_cvt_pk_bf16_f32 v36, v36, v37
    v_cvt_pk_bf16_f32 v38, v38, v39
    v_and_b32 v37, 0xffff0000, v36
    v_lshlrev_b32 v36, 16, v36
    v_and_b32 v39, 0xffff0000, v38
    v_lshlrev_b32 v38, 16, v38
    v_mul_f32 v32, v36, v32
    v_mul_f32 v33, v37, v33
    v_mul_f32 v34, v38, v34
    v_mul_f32 v35, v39, v35
    v_cvt_pk_bf16_f32 v192, v32, v33
    v_cvt_pk_bf16_f32 v193, v34, v35
    ds_write_b64 v10, v[192:193] offset:4096
    v_cvt_pk_bf16_f32 v40, v196, v228
    v_cvt_pk_bf16_f32 v41, v197, v229
    v_cvt_pk_bf16_f32 v42, v198, v230
    v_cvt_pk_bf16_f32 v43, v199, v231
    v_lshlrev_b32 v44, 16, v40
    v_lshlrev_b32 v45, 16, v41
    v_lshlrev_b32 v46, 16, v42
    v_lshlrev_b32 v47, 16, v43
    v_mul_f32 v44, s23, v44
    v_mul_f32 v45, s23, v45
    v_mul_f32 v46, s23, v46
    v_mul_f32 v47, s23, v47
    v_exp_f32 v44, v44
    v_exp_f32 v45, v45
    v_exp_f32 v46, v46
    v_exp_f32 v47, v47
    v_add_f32 v44, 1.0, v44
    v_add_f32 v45, 1.0, v45
    v_add_f32 v46, 1.0, v46
    v_add_f32 v47, 1.0, v47
    v_rcp_f32 v44, v44
    v_rcp_f32 v45, v45
    v_rcp_f32 v46, v46
    v_rcp_f32 v47, v47
    v_and_b32 v40, 0xffff0000, v40
    v_and_b32 v41, 0xffff0000, v41
    v_and_b32 v42, 0xffff0000, v42
    v_and_b32 v43, 0xffff0000, v43
    v_cvt_pk_bf16_f32 v44, v44, v45
    v_cvt_pk_bf16_f32 v46, v46, v47
    v_and_b32 v45, 0xffff0000, v44
    v_lshlrev_b32 v44, 16, v44
    v_and_b32 v47, 0xffff0000, v46
    v_lshlrev_b32 v46, 16, v46
    v_mul_f32 v40, v44, v40
    v_mul_f32 v41, v45, v41
    v_mul_f32 v42, v46, v42
    v_mul_f32 v43, v47, v43
    v_cvt_pk_bf16_f32 v196, v40, v41
    v_cvt_pk_bf16_f32 v197, v42, v43
    v_xor_b32 v13, 0x10, v10
    ds_write_b64 v13, v[196:197] offset:4096
    v_cvt_pk_bf16_f32 v32, v200, v232
    v_cvt_pk_bf16_f32 v33, v201, v233
    v_cvt_pk_bf16_f32 v34, v202, v234
    v_cvt_pk_bf16_f32 v35, v203, v235
    v_lshlrev_b32 v36, 16, v32
    v_lshlrev_b32 v37, 16, v33
    v_lshlrev_b32 v38, 16, v34
    v_lshlrev_b32 v39, 16, v35
    v_mul_f32 v36, s23, v36
    v_mul_f32 v37, s23, v37
    v_mul_f32 v38, s23, v38
    v_mul_f32 v39, s23, v39
    v_exp_f32 v36, v36
    v_exp_f32 v37, v37
    v_exp_f32 v38, v38
    v_exp_f32 v39, v39
    v_add_f32 v36, 1.0, v36
    v_add_f32 v37, 1.0, v37
    v_add_f32 v38, 1.0, v38
    v_add_f32 v39, 1.0, v39
    v_rcp_f32 v36, v36
    v_rcp_f32 v37, v37
    v_rcp_f32 v38, v38
    v_rcp_f32 v39, v39
    v_and_b32 v32, 0xffff0000, v32
    v_and_b32 v33, 0xffff0000, v33
    v_and_b32 v34, 0xffff0000, v34
    v_and_b32 v35, 0xffff0000, v35
    v_cvt_pk_bf16_f32 v36, v36, v37
    v_cvt_pk_bf16_f32 v38, v38, v39
    v_and_b32 v37, 0xffff0000, v36
    v_lshlrev_b32 v36, 16, v36
    v_and_b32 v39, 0xffff0000, v38
    v_lshlrev_b32 v38, 16, v38
    v_mul_f32 v32, v36, v32
    v_mul_f32 v33, v37, v33
    v_mul_f32 v34, v38, v34
    v_mul_f32 v35, v39, v35
    v_cvt_pk_bf16_f32 v200, v32, v33
    v_cvt_pk_bf16_f32 v201, v34, v35
    v_xor_b32 v13, 0x20, v10
    ds_write_b64 v13, v[200:201] offset:4096
    v_cvt_pk_bf16_f32 v40, v204, v236
    v_cvt_pk_bf16_f32 v41, v205, v237
    v_cvt_pk_bf16_f32 v42, v206, v238
    v_cvt_pk_bf16_f32 v43, v207, v239
    v_lshlrev_b32 v44, 16, v40
    v_lshlrev_b32 v45, 16, v41
    v_lshlrev_b32 v46, 16, v42
    v_lshlrev_b32 v47, 16, v43
    v_mul_f32 v44, s23, v44
    v_mul_f32 v45, s23, v45
    v_mul_f32 v46, s23, v46
    v_mul_f32 v47, s23, v47
    v_exp_f32 v44, v44
    v_exp_f32 v45, v45
    v_exp_f32 v46, v46
    v_exp_f32 v47, v47
    v_add_f32 v44, 1.0, v44
    v_add_f32 v45, 1.0, v45
    v_add_f32 v46, 1.0, v46
    v_add_f32 v47, 1.0, v47
    v_rcp_f32 v44, v44
    v_rcp_f32 v45, v45
    v_rcp_f32 v46, v46
    v_rcp_f32 v47, v47
    v_and_b32 v40, 0xffff0000, v40
    v_and_b32 v41, 0xffff0000, v41
    v_and_b32 v42, 0xffff0000, v42
    v_and_b32 v43, 0xffff0000, v43
    v_cvt_pk_bf16_f32 v44, v44, v45
    v_cvt_pk_bf16_f32 v46, v46, v47
    v_and_b32 v45, 0xffff0000, v44
    v_lshlrev_b32 v44, 16, v44
    v_and_b32 v47, 0xffff0000, v46
    v_lshlrev_b32 v46, 16, v46
    v_mul_f32 v40, v44, v40
    v_mul_f32 v41, v45, v41
    v_mul_f32 v42, v46, v42
    v_mul_f32 v43, v47, v43
    v_cvt_pk_bf16_f32 v204, v40, v41
    v_cvt_pk_bf16_f32 v205, v42, v43
    v_xor_b32 v13, 0x30, v10
    ds_write_b64 v13, v[204:205] offset:4096
    v_cvt_pk_bf16_f32 v32, v208, v240
    v_cvt_pk_bf16_f32 v33, v209, v241
    v_cvt_pk_bf16_f32 v34, v210, v242
    v_cvt_pk_bf16_f32 v35, v211, v243
    v_lshlrev_b32 v36, 16, v32
    v_lshlrev_b32 v37, 16, v33
    v_lshlrev_b32 v38, 16, v34
    v_lshlrev_b32 v39, 16, v35
    v_mul_f32 v36, s23, v36
    v_mul_f32 v37, s23, v37
    v_mul_f32 v38, s23, v38
    v_mul_f32 v39, s23, v39
    v_exp_f32 v36, v36
    v_exp_f32 v37, v37
    v_exp_f32 v38, v38
    v_exp_f32 v39, v39
    v_add_f32 v36, 1.0, v36
    v_add_f32 v37, 1.0, v37
    v_add_f32 v38, 1.0, v38
    v_add_f32 v39, 1.0, v39
    v_rcp_f32 v36, v36
    v_rcp_f32 v37, v37
    v_rcp_f32 v38, v38
    v_rcp_f32 v39, v39
    v_and_b32 v32, 0xffff0000, v32
    v_and_b32 v33, 0xffff0000, v33
    v_and_b32 v34, 0xffff0000, v34
    v_and_b32 v35, 0xffff0000, v35
    v_cvt_pk_bf16_f32 v36, v36, v37
    v_cvt_pk_bf16_f32 v38, v38, v39
    v_and_b32 v37, 0xffff0000, v36
    v_lshlrev_b32 v36, 16, v36
    v_and_b32 v39, 0xffff0000, v38
    v_lshlrev_b32 v38, 16, v38
    v_mul_f32 v32, v36, v32
    v_mul_f32 v33, v37, v33
    v_mul_f32 v34, v38, v34
    v_mul_f32 v35, v39, v35
    v_cvt_pk_bf16_f32 v208, v32, v33
    v_cvt_pk_bf16_f32 v209, v34, v35
    v_xor_b32 v13, 0x40, v10
    ds_write_b64 v13, v[208:209] offset:4096
    v_cvt_pk_bf16_f32 v40, v212, v244
    v_cvt_pk_bf16_f32 v41, v213, v245
    v_cvt_pk_bf16_f32 v42, v214, v246
    v_cvt_pk_bf16_f32 v43, v215, v247
    v_lshlrev_b32 v44, 16, v40
    v_lshlrev_b32 v45, 16, v41
    v_lshlrev_b32 v46, 16, v42
    v_lshlrev_b32 v47, 16, v43
    v_mul_f32 v44, s23, v44
    v_mul_f32 v45, s23, v45
    v_mul_f32 v46, s23, v46
    v_mul_f32 v47, s23, v47
    v_exp_f32 v44, v44
    v_exp_f32 v45, v45
    v_exp_f32 v46, v46
    v_exp_f32 v47, v47
    v_add_f32 v44, 1.0, v44
    v_add_f32 v45, 1.0, v45
    v_add_f32 v46, 1.0, v46
    v_add_f32 v47, 1.0, v47
    v_rcp_f32 v44, v44
    v_rcp_f32 v45, v45
    v_rcp_f32 v46, v46
    v_rcp_f32 v47, v47
    v_and_b32 v40, 0xffff0000, v40
    v_and_b32 v41, 0xffff0000, v41
    v_and_b32 v42, 0xffff0000, v42
    v_and_b32 v43, 0xffff0000, v43
    v_cvt_pk_bf16_f32 v44, v44, v45
    v_cvt_pk_bf16_f32 v46, v46, v47
    v_and_b32 v45, 0xffff0000, v44
    v_lshlrev_b32 v44, 16, v44
    v_and_b32 v47, 0xffff0000, v46
    v_lshlrev_b32 v46, 16, v46
    v_mul_f32 v40, v44, v40
    v_mul_f32 v41, v45, v41
    v_mul_f32 v42, v46, v42
    v_mul_f32 v43, v47, v43
    v_cvt_pk_bf16_f32 v212, v40, v41
    v_cvt_pk_bf16_f32 v213, v42, v43
    v_xor_b32 v13, 0x50, v10
    ds_write_b64 v13, v[212:213] offset:4096
    v_cvt_pk_bf16_f32 v32, v216, v248
    v_cvt_pk_bf16_f32 v33, v217, v249
    v_cvt_pk_bf16_f32 v34, v218, v250
    v_cvt_pk_bf16_f32 v35, v219, v251
    v_lshlrev_b32 v36, 16, v32
    v_lshlrev_b32 v37, 16, v33
    v_lshlrev_b32 v38, 16, v34
    v_lshlrev_b32 v39, 16, v35
    v_mul_f32 v36, s23, v36
    v_mul_f32 v37, s23, v37
    v_mul_f32 v38, s23, v38
    v_mul_f32 v39, s23, v39
    v_exp_f32 v36, v36
    v_exp_f32 v37, v37
    v_exp_f32 v38, v38
    v_exp_f32 v39, v39
    v_add_f32 v36, 1.0, v36
    v_add_f32 v37, 1.0, v37
    v_add_f32 v38, 1.0, v38
    v_add_f32 v39, 1.0, v39
    v_rcp_f32 v36, v36
    v_rcp_f32 v37, v37
    v_rcp_f32 v38, v38
    v_rcp_f32 v39, v39
    v_and_b32 v32, 0xffff0000, v32
    v_and_b32 v33, 0xffff0000, v33
    v_and_b32 v34, 0xffff0000, v34
    v_and_b32 v35, 0xffff0000, v35
    v_cvt_pk_bf16_f32 v36, v36, v37
    v_cvt_pk_bf16_f32 v38, v38, v39
    v_and_b32 v37, 0xffff0000, v36
    v_lshlrev_b32 v36, 16, v36
    v_and_b32 v39, 0xffff0000, v38
    v_lshlrev_b32 v38, 16, v38
    v_mul_f32 v32, v36, v32
    v_mul_f32 v33, v37, v33
    v_mul_f32 v34, v38, v34
    v_mul_f32 v35, v39, v35
    v_cvt_pk_bf16_f32 v216, v32, v33
    v_cvt_pk_bf16_f32 v217, v34, v35
    v_xor_b32 v13, 0x60, v10
    ds_write_b64 v13, v[216:217] offset:4096
    v_cvt_pk_bf16_f32 v40, v220, v252
    v_cvt_pk_bf16_f32 v41, v221, v253
    v_cvt_pk_bf16_f32 v42, v222, v254
    v_cvt_pk_bf16_f32 v43, v223, v255
    v_lshlrev_b32 v44, 16, v40
    v_lshlrev_b32 v45, 16, v41
    v_lshlrev_b32 v46, 16, v42
    v_lshlrev_b32 v47, 16, v43
    v_mul_f32 v44, s23, v44
    v_mul_f32 v45, s23, v45
    v_mul_f32 v46, s23, v46
    v_mul_f32 v47, s23, v47
    v_exp_f32 v44, v44
    v_exp_f32 v45, v45
    v_exp_f32 v46, v46
    v_exp_f32 v47, v47
    v_add_f32 v44, 1.0, v44
    v_add_f32 v45, 1.0, v45
    v_add_f32 v46, 1.0, v46
    v_add_f32 v47, 1.0, v47
    v_rcp_f32 v44, v44
    v_rcp_f32 v45, v45
    v_rcp_f32 v46, v46
    v_rcp_f32 v47, v47
    v_and_b32 v40, 0xffff0000, v40
    v_and_b32 v41, 0xffff0000, v41
    v_and_b32 v42, 0xffff0000, v42
    v_and_b32 v43, 0xffff0000, v43
    v_cvt_pk_bf16_f32 v44, v44, v45
    v_cvt_pk_bf16_f32 v46, v46, v47
    v_and_b32 v45, 0xffff0000, v44
    v_lshlrev_b32 v44, 16, v44
    v_and_b32 v47, 0xffff0000, v46
    v_lshlrev_b32 v46, 16, v46
    v_mul_f32 v40, v44, v40
    v_mul_f32 v41, v45, v41
    v_mul_f32 v42, v46, v42
    v_mul_f32 v43, v47, v43
    v_cvt_pk_bf16_f32 v220, v40, v41
    v_cvt_pk_bf16_f32 v221, v42, v43
    v_xor_b32 v13, 0x70, v10
    ds_write_b64 v13, v[220:221] offset:4096
    s_waitcnt lgkmcnt(0)
    ds_read_b128 v[128:131], v11 offset:0
    ds_read_b128 v[132:135], v11 offset:1024
    ds_read_b128 v[136:139], v11 offset:2048
    ds_read_b128 v[140:143], v11 offset:3072
    ds_read_b128 v[144:147], v11 offset:4096
    ds_read_b128 v[148:151], v11 offset:5120
    ds_read_b128 v[152:155], v11 offset:6144
    ds_read_b128 v[156:159], v11 offset:7168
    s_waitcnt lgkmcnt(7)
    buffer_store_dwordx4 v[128:131], v12, s[12:15], 0 offen sc1
    v_add_u32 v12, 0xe000, v12
    s_waitcnt lgkmcnt(6)
    buffer_store_dwordx4 v[132:135], v12, s[12:15], 0 offen sc1
    v_add_u32 v12, 0xe000, v12
    s_waitcnt lgkmcnt(5)
    buffer_store_dwordx4 v[136:139], v12, s[12:15], 0 offen sc1
    v_add_u32 v12, 0xe000, v12
    s_waitcnt lgkmcnt(4)
    buffer_store_dwordx4 v[140:143], v12, s[12:15], 0 offen sc1
    v_add_u32 v12, 0xe000, v12
    s_waitcnt lgkmcnt(3)
    buffer_store_dwordx4 v[144:147], v12, s[12:15], 0 offen sc1
    v_add_u32 v12, 0xe000, v12
    s_waitcnt lgkmcnt(2)
    buffer_store_dwordx4 v[148:151], v12, s[12:15], 0 offen sc1
    v_add_u32 v12, 0xe000, v12
    s_waitcnt lgkmcnt(1)
    buffer_store_dwordx4 v[152:155], v12, s[12:15], 0 offen sc1
    v_add_u32 v12, 0xe000, v12
    s_waitcnt lgkmcnt(0)
    buffer_store_dwordx4 v[156:159], v12, s[12:15], 0 offen sc1
il_g3_kernel_end_1:
    s_endpgm
.globl il_g4_kernel
.p2align 8
.type il_g4_kernel,@function
il_g4_kernel:
    s_cmp_ge_u32 s2, 256
    s_cbranch_scc1 il_g4_kernel_end_1
    s_load_dwordx2 s[38:39], s[0:1], 88
    s_load_dwordx2 s[28:29], s[0:1], 64
    s_and_b32 s23, s2, 7
    s_lshr_b32 s3, s2, 3
    s_mul_i32 s16, s23, 32
    s_add_u32 s16, s16, s3
    s_and_b32 s23, s16, 31
    s_lshr_b32 s3, s16, 5
    s_lshr_b32 s19, s3, 2
    s_and_b32 s3, s3, 3
    s_lshr_b32 s17, s3, 0
    s_and_b32 s18, s3, 0
    s_lshl_b32 s17, s17, 2
    s_lshl_b32 s18, s18, 3
    s_lshr_b32 s3, s23, 3
    s_add_u32 s17, s17, s3
    s_and_b32 s3, s23, 7
    s_add_u32 s18, s18, s3
    v_lshrrev_b32 v1, 6, v0
    v_and_b32 v2, 63, v0
    s_nop 0
    v_readfirstlane_b32 s20, v1
    s_nop 3
    s_lshr_b32 s21, s20, 1
    s_and_b32 s22, s20, 1
    s_waitcnt lgkmcnt(0)
    s_cmp_eq_u32 s19, 0
    s_mov_b32 s23, 0x1800000
    s_mov_b32 s3, 0x1800e00
    s_cselect_b32 s23, s23, s3
    s_add_u32 s56, s38, s23
    s_addc_u32 s57, s39, 0
    s_mul_i32 s23, s17, 128
    s_mul_i32 s3, s20, 32
    s_add_u32 s23, s23, s3
    s_mul_i32 s23, s23, 7168
    s_add_u32 s4, s56, s23
    s_addc_u32 s5, s57, 0
    s_sub_u32 s6, 0xdff200, s23
    s_and_b32 s5, s5, 0xffff
    s_mov_b32 s7, 0x20000
    s_mul_i32 s23, s20, 4
    s_and_b32 s3, s23, 7
    s_lshr_b32 s23, s23, 3
    s_mul_i32 s3, s3, 16384
    s_mul_i32 s23, s23, 128
    s_add_u32 s23, s23, s3
    s_mul_i32 s3, s18, 256
    s_add_u32 s23, s23, s3
    s_mov_b32 s62, s23
    s_cmp_eq_u32 s19, 0
    s_mov_b32 s23, 0x0
    s_mov_b32 s3, 0x380000
    s_cselect_b32 s23, s23, s3
    s_add_u32 s58, s28, s23
    s_addc_u32 s59, s29, 0
    s_add_u32 s8, s58, s62
    s_addc_u32 s9, s59, 0
    s_sub_u32 s10, 0x380000, s62
    s_and_b32 s9, s9, 0xffff
    s_mov_b32 s11, 0x20000
    s_cmp_eq_u32 s19, 0
    s_mov_b32 s23, 0x2800000
    s_mov_b32 s3, 0x3000000
    s_cselect_b32 s23, s23, s3
    s_add_u32 s60, s38, s23
    s_addc_u32 s61, s39, 0
    s_mul_i32 s23, s17, 524288
    s_mul_i32 s3, s18, 512
    s_add_u32 s23, s23, s3
    s_add_u32 s12, s60, s23
    s_addc_u32 s13, s61, 0
    s_sub_u32 s14, 0x800000, s23
    s_and_b32 s13, s13, 0xffff
    s_mov_b32 s15, 0x20000
    v_lshrrev_b32 v3, 3, v2
    v_and_b32 v4, 7, v2
    v_lshrrev_b32 v5, 4, v2
    v_mul_u32_u24 v6, 0x1c00, v3
    v_xor_b32 v7, v5, v4
    v_lshl_add_u32 v16, v7, 4, v6
    v_or_b32 v7, 4, v5
    v_xor_b32 v7, v7, v4
    v_lshl_add_u32 v17, v7, 4, v6
    v_add_u32 v17, 0xdc00, v17
    v_xor_b32 v7, v5, v4
    v_lshl_add_u32 v18, v7, 4, v6
    v_add_u32 v18, 0x1b800, v18
    v_or_b32 v7, 4, v5
    v_xor_b32 v7, v7, v4
    v_lshl_add_u32 v19, v7, 4, v6
    v_add_u32 v19, 0x29400, v19
    v_and_b32 v7, 1, v5
    v_lshlrev_b32 v7, 2, v7
    v_xor_b32 v7, v7, v4
    v_mul_u32_u24 v6, 0x800, v3
    v_lshl_add_u32 v20, v7, 4, v6
    v_lshl_add_u32 v21, v7, 4, v6
    v_add_u32 v21, 0x3c00, v21
    v_lshl_add_u32 v22, v7, 4, v6
    v_add_u32 v22, 0x7800, v22
    v_lshl_add_u32 v23, v7, 4, v6
    v_add_u32 v23, 0xb400, v23
    v_and_b32 v8, 31, v2
    v_lshrrev_b32 v9, 5, v2
    v_lshrrev_b32 v10, 1, v8
    v_and_b32 v10, 7, v10
    v_xor_b32 v10, v10, v9
    v_lshlrev_b32 v10, 4, v10
    v_lshl_add_u32 v10, v8, 7, v10
    s_mul_i32 s23, s21, 8192
    v_xor_b32 v24, 0x0, v10
    v_add_u32 v24, s23, v24
    v_xor_b32 v25, 0x20, v10
    v_add_u32 v25, s23, v25
    v_xor_b32 v26, 0x40, v10
    v_add_u32 v26, s23, v26
    v_xor_b32 v27, 0x60, v10
    v_add_u32 v27, s23, v27
    v_lshrrev_b32 v11, 2, v2
    v_and_b32 v11, 3, v11
    v_lshl_add_u32 v11, v9, 3, v11
    v_and_b32 v12, 1, v5
    v_lshlrev_b32 v12, 1, v12
    v_lshrrev_b32 v13, 1, v2
    v_and_b32 v13, 1, v13
    v_add_u32 v12, v12, v13
    v_and_b32 v13, 1, v3
    v_lshlrev_b32 v13, 2, v13
    v_and_b32 v14, 1, v2
    s_mul_i32 s23, s22, 2
    s_add_u32 s23, s23, 0
    s_and_b32 s3, s23, 1
    s_lshl_b32 s3, s3, 2
    v_add_u32 v15, s3, v12
    v_xor_b32 v15, v15, v13
    v_lshlrev_b32 v15, 4, v15
    v_lshl_add_u32 v15, v11, 7, v15
    v_lshl_add_u32 v15, v14, 3, v15
    s_lshr_b32 s23, s23, 1
    s_lshl_b32 s23, s23, 13
    s_add_u32 s23, s23, 0x10000
    v_add_u32 v28, s23, v15
    s_mul_i32 s23, s22, 2
    s_add_u32 s23, s23, 1
    s_and_b32 s3, s23, 1
    s_lshl_b32 s3, s3, 2
    v_add_u32 v15, s3, v12
    v_xor_b32 v15, v15, v13
    v_lshlrev_b32 v15, 4, v15
    v_lshl_add_u32 v15, v11, 7, v15
    v_lshl_add_u32 v15, v14, 3, v15
    s_lshr_b32 s23, s23, 1
    s_lshl_b32 s23, s23, 13
    s_add_u32 s23, s23, 0x10000
    v_add_u32 v29, s23, v15
    s_mul_i32 s23, s20, 4096
    s_add_u32 s40, s23, 0x0
    s_mul_i32 s23, s20, 4096
    s_add_u32 s48, s23, 0x10000
    s_mul_i32 s23, s20, 4096
    s_add_u32 s41, s23, 0x4000
    s_mul_i32 s23, s20, 4096
    s_add_u32 s49, s23, 0x14000
    s_mul_i32 s23, s20, 4096
    s_add_u32 s42, s23, 0x8000
    s_mul_i32 s23, s20, 4096
    s_add_u32 s50, s23, 0x18000
    s_mul_i32 s23, s20, 4096
    s_add_u32 s43, s23, 0xc000
    s_mul_i32 s23, s20, 4096
    s_add_u32 s51, s23, 0x1c000
    s_mov_b32 s34, 0
    s_mov_b32 s35, 0
    s_mov_b32 m0, s40
    s_nop 0
    buffer_load_dwordx4 v16, s[4:7], s34 offen offset:0 lds
    buffer_load_dwordx4 v17, s[4:7], s34 offen offset:1024 lds
    buffer_load_dwordx4 v18, s[4:7], s34 offen offset:2048 lds
    buffer_load_dwordx4 v19, s[4:7], s34 offen offset:3072 lds
    s_mov_b32 m0, s48
    s_nop 0
    buffer_load_dwordx4 v20, s[8:11], s35 offen offset:0 lds
    buffer_load_dwordx4 v21, s[8:11], s35 offen offset:1024 lds
    buffer_load_dwordx4 v22, s[8:11], s35 offen offset:2048 lds
    buffer_load_dwordx4 v23, s[8:11], s35 offen offset:3072 lds
    s_add_u32 s34, s34, 128
    s_add_u32 s35, s35, 0x20000
    s_mov_b32 m0, s41
    s_nop 0
    buffer_load_dwordx4 v16, s[4:7], s34 offen offset:0 lds
    buffer_load_dwordx4 v17, s[4:7], s34 offen offset:1024 lds
    buffer_load_dwordx4 v18, s[4:7], s34 offen offset:2048 lds
    buffer_load_dwordx4 v19, s[4:7], s34 offen offset:3072 lds
    s_mov_b32 m0, s49
    s_nop 0
    buffer_load_dwordx4 v20, s[8:11], s35 offen offset:0 lds
    buffer_load_dwordx4 v21, s[8:11], s35 offen offset:1024 lds
    buffer_load_dwordx4 v22, s[8:11], s35 offen offset:2048 lds
    buffer_load_dwordx4 v23, s[8:11], s35 offen offset:3072 lds
    s_add_u32 s34, s34, 128
    s_add_u32 s35, s35, 0x20000
    s_mov_b32 m0, s42
    s_nop 0
    buffer_load_dwordx4 v16, s[4:7], s34 offen offset:0 lds
    buffer_load_dwordx4 v17, s[4:7], s34 offen offset:1024 lds
    buffer_load_dwordx4 v18, s[4:7], s34 offen offset:2048 lds
    buffer_load_dwordx4 v19, s[4:7], s34 offen offset:3072 lds
    s_mov_b32 m0, s50
    s_nop 0
    buffer_load_dwordx4 v20, s[8:11], s35 offen offset:0 lds
    buffer_load_dwordx4 v21, s[8:11], s35 offen offset:1024 lds
    buffer_load_dwordx4 v22, s[8:11], s35 offen offset:2048 lds
    buffer_load_dwordx4 v23, s[8:11], s35 offen offset:3072 lds
    s_add_u32 s34, s34, 128
    s_add_u32 s35, s35, 0x20000
    v_mov_b32 v96, 0
    v_mov_b32 v97, 0
    v_mov_b32 v98, 0
    v_mov_b32 v99, 0
    v_mov_b32 v100, 0
    v_mov_b32 v101, 0
    v_mov_b32 v102, 0
    v_mov_b32 v103, 0
    v_mov_b32 v104, 0
    v_mov_b32 v105, 0
    v_mov_b32 v106, 0
    v_mov_b32 v107, 0
    v_mov_b32 v108, 0
    v_mov_b32 v109, 0
    v_mov_b32 v110, 0
    v_mov_b32 v111, 0
    v_mov_b32 v112, 0
    v_mov_b32 v113, 0
    v_mov_b32 v114, 0
    v_mov_b32 v115, 0
    v_mov_b32 v116, 0
    v_mov_b32 v117, 0
    v_mov_b32 v118, 0
    v_mov_b32 v119, 0
    v_mov_b32 v120, 0
    v_mov_b32 v121, 0
    v_mov_b32 v122, 0
    v_mov_b32 v123, 0
    v_mov_b32 v124, 0
    v_mov_b32 v125, 0
    v_mov_b32 v126, 0
    v_mov_b32 v127, 0
    v_mov_b32 v128, 0
    v_mov_b32 v129, 0
    v_mov_b32 v130, 0
    v_mov_b32 v131, 0
    v_mov_b32 v132, 0
    v_mov_b32 v133, 0
    v_mov_b32 v134, 0
    v_mov_b32 v135, 0
    v_mov_b32 v136, 0
    v_mov_b32 v137, 0
    v_mov_b32 v138, 0
    v_mov_b32 v139, 0
    v_mov_b32 v140, 0
    v_mov_b32 v141, 0
    v_mov_b32 v142, 0
    v_mov_b32 v143, 0
    v_mov_b32 v144, 0
    v_mov_b32 v145, 0
    v_mov_b32 v146, 0
    v_mov_b32 v147, 0
    v_mov_b32 v148, 0
    v_mov_b32 v149, 0
    v_mov_b32 v150, 0
    v_mov_b32 v151, 0
    v_mov_b32 v152, 0
    v_mov_b32 v153, 0
    v_mov_b32 v154, 0
    v_mov_b32 v155, 0
    v_mov_b32 v156, 0
    v_mov_b32 v157, 0
    v_mov_b32 v158, 0
    v_mov_b32 v159, 0
    s_waitcnt vmcnt(16)
    s_barrier
    ds_read_b128 v[32:35], v24 offset:0
    ds_read_b128 v[36:39], v24 offset:4096
    ds_read_b64_tr_b16 v[40:41], v28 offset:0
    ds_read_b64_tr_b16 v[42:43], v28 offset:512
    ds_read_b64_tr_b16 v[44:45], v29 offset:0
    ds_read_b64_tr_b16 v[46:47], v29 offset:512
    ds_read_b128 v[48:51], v25 offset:0
    ds_read_b128 v[52:55], v25 offset:4096
    ds_read_b64_tr_b16 v[56:57], v28 offset:2048
    ds_read_b64_tr_b16 v[58:59], v28 offset:2560
    ds_read_b64_tr_b16 v[60:61], v29 offset:2048
    ds_read_b64_tr_b16 v[62:63], v29 offset:2560
    s_mov_b32 s36, 6
il_g4_kernel_loop_2:
    s_waitcnt lgkmcnt(6)
    v_mfma_f32_32x32x16_bf16 v[96:111], v[40:43], v[32:35], v[96:111]
    ds_read_b128 v[64:67], v26 offset:0
    s_mov_b32 m0, s43
    s_nop 0
    buffer_load_dwordx4 v16, s[4:7], s34 offen offset:0 lds
    v_mfma_f32_32x32x16_bf16 v[112:127], v[44:47], v[32:35], v[112:127]
    ds_read_b128 v[68:71], v26 offset:4096
    ds_read_b64_tr_b16 v[72:73], v28 offset:4096
    v_mfma_f32_32x32x16_bf16 v[128:143], v[40:43], v[36:39], v[128:143]
    ds_read_b64_tr_b16 v[74:75], v28 offset:4608
    buffer_load_dwordx4 v17, s[4:7], s34 offen offset:1024 lds
    v_mfma_f32_32x32x16_bf16 v[144:159], v[44:47], v[36:39], v[144:159]
    ds_read_b64_tr_b16 v[76:77], v29 offset:4096
    ds_read_b64_tr_b16 v[78:79], v29 offset:4608
    s_waitcnt lgkmcnt(6)
    v_mfma_f32_32x32x16_bf16 v[96:111], v[56:59], v[48:51], v[96:111]
    ds_read_b128 v[80:83], v27 offset:0
    buffer_load_dwordx4 v18, s[4:7], s34 offen offset:2048 lds
    v_mfma_f32_32x32x16_bf16 v[112:127], v[60:63], v[48:51], v[112:127]
    ds_read_b128 v[84:87], v27 offset:4096
    ds_read_b64_tr_b16 v[88:89], v28 offset:6144
    v_mfma_f32_32x32x16_bf16 v[128:143], v[56:59], v[52:55], v[128:143]
    ds_read_b64_tr_b16 v[90:91], v28 offset:6656
    buffer_load_dwordx4 v19, s[4:7], s34 offen offset:3072 lds
    v_mfma_f32_32x32x16_bf16 v[144:159], v[60:63], v[52:55], v[144:159]
    ds_read_b64_tr_b16 v[92:93], v29 offset:6144
    ds_read_b64_tr_b16 v[94:95], v29 offset:6656
    s_waitcnt lgkmcnt(6)
    v_mfma_f32_32x32x16_bf16 v[96:111], v[72:75], v[64:67], v[96:111]
    s_mov_b32 m0, s51
    s_nop 0
    buffer_load_dwordx4 v20, s[8:11], s35 offen offset:0 lds
    v_mfma_f32_32x32x16_bf16 v[112:127], v[76:79], v[64:67], v[112:127]
    buffer_load_dwordx4 v21, s[8:11], s35 offen offset:1024 lds
    v_mfma_f32_32x32x16_bf16 v[128:143], v[72:75], v[68:71], v[128:143]
    buffer_load_dwordx4 v22, s[8:11], s35 offen offset:2048 lds
    v_mfma_f32_32x32x16_bf16 v[144:159], v[76:79], v[68:71], v[144:159]
    buffer_load_dwordx4 v23, s[8:11], s35 offen offset:3072 lds
    s_add_u32 s34, s34, 128
    s_add_u32 s35, s35, 0x20000
    s_waitcnt lgkmcnt(0)
    s_waitcnt vmcnt(16) lgkmcnt(0)
    s_barrier
    v_mfma_f32_32x32x16_bf16 v[96:111], v[88:91], v[80:83], v[96:111]
    ds_read_b128 v[32:35], v24 offset:16384
    ds_read_b128 v[36:39], v24 offset:20480
    ds_read_b64_tr_b16 v[40:41], v28 offset:16384
    v_mfma_f32_32x32x16_bf16 v[112:127], v[92:95], v[80:83], v[112:127]
    ds_read_b64_tr_b16 v[42:43], v28 offset:16896
    ds_read_b64_tr_b16 v[44:45], v29 offset:16384
    ds_read_b64_tr_b16 v[46:47], v29 offset:16896
    v_mfma_f32_32x32x16_bf16 v[128:143], v[88:91], v[84:87], v[128:143]
    ds_read_b128 v[48:51], v25 offset:16384
    ds_read_b128 v[52:55], v25 offset:20480
    ds_read_b64_tr_b16 v[56:57], v28 offset:18432
    v_mfma_f32_32x32x16_bf16 v[144:159], v[92:95], v[84:87], v[144:159]
    ds_read_b64_tr_b16 v[58:59], v28 offset:18944
    ds_read_b64_tr_b16 v[60:61], v29 offset:18432
    ds_read_b64_tr_b16 v[62:63], v29 offset:18944
    s_waitcnt lgkmcnt(6)
    v_mfma_f32_32x32x16_bf16 v[96:111], v[40:43], v[32:35], v[96:111]
    ds_read_b128 v[64:67], v26 offset:16384
    s_mov_b32 m0, s40
    s_nop 0
    buffer_load_dwordx4 v16, s[4:7], s34 offen offset:0 lds
    v_mfma_f32_32x32x16_bf16 v[112:127], v[44:47], v[32:35], v[112:127]
    ds_read_b128 v[68:71], v26 offset:20480
    ds_read_b64_tr_b16 v[72:73], v28 offset:20480
    v_mfma_f32_32x32x16_bf16 v[128:143], v[40:43], v[36:39], v[128:143]
    ds_read_b64_tr_b16 v[74:75], v28 offset:20992
    buffer_load_dwordx4 v17, s[4:7], s34 offen offset:1024 lds
    v_mfma_f32_32x32x16_bf16 v[144:159], v[44:47], v[36:39], v[144:159]
    ds_read_b64_tr_b16 v[76:77], v29 offset:20480
    ds_read_b64_tr_b16 v[78:79], v29 offset:20992
    s_waitcnt lgkmcnt(6)
    v_mfma_f32_32x32x16_bf16 v[96:111], v[56:59], v[48:51], v[96:111]
    ds_read_b128 v[80:83], v27 offset:16384
    buffer_load_dwordx4 v18, s[4:7], s34 offen offset:2048 lds
    v_mfma_f32_32x32x16_bf16 v[112:127], v[60:63], v[48:51], v[112:127]
    ds_read_b128 v[84:87], v27 offset:20480
    ds_read_b64_tr_b16 v[88:89], v28 offset:22528
    v_mfma_f32_32x32x16_bf16 v[128:143], v[56:59], v[52:55], v[128:143]
    ds_read_b64_tr_b16 v[90:91], v28 offset:23040
    buffer_load_dwordx4 v19, s[4:7], s34 offen offset:3072 lds
    v_mfma_f32_32x32x16_bf16 v[144:159], v[60:63], v[52:55], v[144:159]
    ds_read_b64_tr_b16 v[92:93], v29 offset:22528
    ds_read_b64_tr_b16 v[94:95], v29 offset:23040
    s_waitcnt lgkmcnt(6)
    v_mfma_f32_32x32x16_bf16 v[96:111], v[72:75], v[64:67], v[96:111]
    s_mov_b32 m0, s48
    s_nop 0
    buffer_load_dwordx4 v20, s[8:11], s35 offen offset:0 lds
    v_mfma_f32_32x32x16_bf16 v[112:127], v[76:79], v[64:67], v[112:127]
    buffer_load_dwordx4 v21, s[8:11], s35 offen offset:1024 lds
    v_mfma_f32_32x32x16_bf16 v[128:143], v[72:75], v[68:71], v[128:143]
    buffer_load_dwordx4 v22, s[8:11], s35 offen offset:2048 lds
    v_mfma_f32_32x32x16_bf16 v[144:159], v[76:79], v[68:71], v[144:159]
    buffer_load_dwordx4 v23, s[8:11], s35 offen offset:3072 lds
    s_add_u32 s34, s34, 128
    s_add_u32 s35, s35, 0x20000
    s_waitcnt lgkmcnt(0)
    s_waitcnt vmcnt(16) lgkmcnt(0)
    s_barrier
    v_mfma_f32_32x32x16_bf16 v[96:111], v[88:91], v[80:83], v[96:111]
    ds_read_b128 v[32:35], v24 offset:32768
    ds_read_b128 v[36:39], v24 offset:36864
    ds_read_b64_tr_b16 v[40:41], v28 offset:32768
    v_mfma_f32_32x32x16_bf16 v[112:127], v[92:95], v[80:83], v[112:127]
    ds_read_b64_tr_b16 v[42:43], v28 offset:33280
    ds_read_b64_tr_b16 v[44:45], v29 offset:32768
    ds_read_b64_tr_b16 v[46:47], v29 offset:33280
    v_mfma_f32_32x32x16_bf16 v[128:143], v[88:91], v[84:87], v[128:143]
    ds_read_b128 v[48:51], v25 offset:32768
    ds_read_b128 v[52:55], v25 offset:36864
    ds_read_b64_tr_b16 v[56:57], v28 offset:34816
    v_mfma_f32_32x32x16_bf16 v[144:159], v[92:95], v[84:87], v[144:159]
    ds_read_b64_tr_b16 v[58:59], v28 offset:35328
    ds_read_b64_tr_b16 v[60:61], v29 offset:34816
    ds_read_b64_tr_b16 v[62:63], v29 offset:35328
    s_waitcnt lgkmcnt(6)
    v_mfma_f32_32x32x16_bf16 v[96:111], v[40:43], v[32:35], v[96:111]
    ds_read_b128 v[64:67], v26 offset:32768
    s_mov_b32 m0, s41
    s_nop 0
    buffer_load_dwordx4 v16, s[4:7], s34 offen offset:0 lds
    v_mfma_f32_32x32x16_bf16 v[112:127], v[44:47], v[32:35], v[112:127]
    ds_read_b128 v[68:71], v26 offset:36864
    ds_read_b64_tr_b16 v[72:73], v28 offset:36864
    v_mfma_f32_32x32x16_bf16 v[128:143], v[40:43], v[36:39], v[128:143]
    ds_read_b64_tr_b16 v[74:75], v28 offset:37376
    buffer_load_dwordx4 v17, s[4:7], s34 offen offset:1024 lds
    v_mfma_f32_32x32x16_bf16 v[144:159], v[44:47], v[36:39], v[144:159]
    ds_read_b64_tr_b16 v[76:77], v29 offset:36864
    ds_read_b64_tr_b16 v[78:79], v29 offset:37376
    s_waitcnt lgkmcnt(6)
    v_mfma_f32_32x32x16_bf16 v[96:111], v[56:59], v[48:51], v[96:111]
    ds_read_b128 v[80:83], v27 offset:32768
    buffer_load_dwordx4 v18, s[4:7], s34 offen offset:2048 lds
    v_mfma_f32_32x32x16_bf16 v[112:127], v[60:63], v[48:51], v[112:127]
    ds_read_b128 v[84:87], v27 offset:36864
    ds_read_b64_tr_b16 v[88:89], v28 offset:38912
    v_mfma_f32_32x32x16_bf16 v[128:143], v[56:59], v[52:55], v[128:143]
    ds_read_b64_tr_b16 v[90:91], v28 offset:39424
    buffer_load_dwordx4 v19, s[4:7], s34 offen offset:3072 lds
    v_mfma_f32_32x32x16_bf16 v[144:159], v[60:63], v[52:55], v[144:159]
    ds_read_b64_tr_b16 v[92:93], v29 offset:38912
    ds_read_b64_tr_b16 v[94:95], v29 offset:39424
    s_waitcnt lgkmcnt(6)
    v_mfma_f32_32x32x16_bf16 v[96:111], v[72:75], v[64:67], v[96:111]
    s_mov_b32 m0, s49
    s_nop 0
    buffer_load_dwordx4 v20, s[8:11], s35 offen offset:0 lds
    v_mfma_f32_32x32x16_bf16 v[112:127], v[76:79], v[64:67], v[112:127]
    buffer_load_dwordx4 v21, s[8:11], s35 offen offset:1024 lds
    v_mfma_f32_32x32x16_bf16 v[128:143], v[72:75], v[68:71], v[128:143]
    buffer_load_dwordx4 v22, s[8:11], s35 offen offset:2048 lds
    v_mfma_f32_32x32x16_bf16 v[144:159], v[76:79], v[68:71], v[144:159]
    buffer_load_dwordx4 v23, s[8:11], s35 offen offset:3072 lds
    s_add_u32 s34, s34, 128
    s_add_u32 s35, s35, 0x20000
    s_waitcnt lgkmcnt(0)
    s_waitcnt vmcnt(16) lgkmcnt(0)
    s_barrier
    v_mfma_f32_32x32x16_bf16 v[96:111], v[88:91], v[80:83], v[96:111]
    ds_read_b128 v[32:35], v24 offset:49152
    ds_read_b128 v[36:39], v24 offset:53248
    ds_read_b64_tr_b16 v[40:41], v28 offset:49152
    v_mfma_f32_32x32x16_bf16 v[112:127], v[92:95], v[80:83], v[112:127]
    ds_read_b64_tr_b16 v[42:43], v28 offset:49664
    ds_read_b64_tr_b16 v[44:45], v29 offset:49152
    ds_read_b64_tr_b16 v[46:47], v29 offset:49664
    v_mfma_f32_32x32x16_bf16 v[128:143], v[88:91], v[84:87], v[128:143]
    ds_read_b128 v[48:51], v25 offset:49152
    ds_read_b128 v[52:55], v25 offset:53248
    ds_read_b64_tr_b16 v[56:57], v28 offset:51200
    v_mfma_f32_32x32x16_bf16 v[144:159], v[92:95], v[84:87], v[144:159]
    ds_read_b64_tr_b16 v[58:59], v28 offset:51712
    ds_read_b64_tr_b16 v[60:61], v29 offset:51200
    ds_read_b64_tr_b16 v[62:63], v29 offset:51712
    s_waitcnt lgkmcnt(6)
    v_mfma_f32_32x32x16_bf16 v[96:111], v[40:43], v[32:35], v[96:111]
    ds_read_b128 v[64:67], v26 offset:49152
    s_mov_b32 m0, s42
    s_nop 0
    buffer_load_dwordx4 v16, s[4:7], s34 offen offset:0 lds
    v_mfma_f32_32x32x16_bf16 v[112:127], v[44:47], v[32:35], v[112:127]
    ds_read_b128 v[68:71], v26 offset:53248
    ds_read_b64_tr_b16 v[72:73], v28 offset:53248
    v_mfma_f32_32x32x16_bf16 v[128:143], v[40:43], v[36:39], v[128:143]
    ds_read_b64_tr_b16 v[74:75], v28 offset:53760
    buffer_load_dwordx4 v17, s[4:7], s34 offen offset:1024 lds
    v_mfma_f32_32x32x16_bf16 v[144:159], v[44:47], v[36:39], v[144:159]
    ds_read_b64_tr_b16 v[76:77], v29 offset:53248
    ds_read_b64_tr_b16 v[78:79], v29 offset:53760
    s_waitcnt lgkmcnt(6)
    v_mfma_f32_32x32x16_bf16 v[96:111], v[56:59], v[48:51], v[96:111]
    ds_read_b128 v[80:83], v27 offset:49152
    buffer_load_dwordx4 v18, s[4:7], s34 offen offset:2048 lds
    v_mfma_f32_32x32x16_bf16 v[112:127], v[60:63], v[48:51], v[112:127]
    ds_read_b128 v[84:87], v27 offset:53248
    ds_read_b64_tr_b16 v[88:89], v28 offset:55296
    v_mfma_f32_32x32x16_bf16 v[128:143], v[56:59], v[52:55], v[128:143]
    ds_read_b64_tr_b16 v[90:91], v28 offset:55808
    buffer_load_dwordx4 v19, s[4:7], s34 offen offset:3072 lds
    v_mfma_f32_32x32x16_bf16 v[144:159], v[60:63], v[52:55], v[144:159]
    ds_read_b64_tr_b16 v[92:93], v29 offset:55296
    ds_read_b64_tr_b16 v[94:95], v29 offset:55808
    s_waitcnt lgkmcnt(6)
    v_mfma_f32_32x32x16_bf16 v[96:111], v[72:75], v[64:67], v[96:111]
    s_mov_b32 m0, s50
    s_nop 0
    buffer_load_dwordx4 v20, s[8:11], s35 offen offset:0 lds
    v_mfma_f32_32x32x16_bf16 v[112:127], v[76:79], v[64:67], v[112:127]
    buffer_load_dwordx4 v21, s[8:11], s35 offen offset:1024 lds
    v_mfma_f32_32x32x16_bf16 v[128:143], v[72:75], v[68:71], v[128:143]
    buffer_load_dwordx4 v22, s[8:11], s35 offen offset:2048 lds
    v_mfma_f32_32x32x16_bf16 v[144:159], v[76:79], v[68:71], v[144:159]
    buffer_load_dwordx4 v23, s[8:11], s35 offen offset:3072 lds
    s_add_u32 s34, s34, 128
    s_add_u32 s35, s35, 0x20000
    s_waitcnt lgkmcnt(0)
    s_waitcnt vmcnt(16) lgkmcnt(0)
    s_barrier
    v_mfma_f32_32x32x16_bf16 v[96:111], v[88:91], v[80:83], v[96:111]
    ds_read_b128 v[32:35], v24 offset:0
    ds_read_b128 v[36:39], v24 offset:4096
    ds_read_b64_tr_b16 v[40:41], v28 offset:0
    v_mfma_f32_32x32x16_bf16 v[112:127], v[92:95], v[80:83], v[112:127]
    ds_read_b64_tr_b16 v[42:43], v28 offset:512
    ds_read_b64_tr_b16 v[44:45], v29 offset:0
    ds_read_b64_tr_b16 v[46:47], v29 offset:512
    v_mfma_f32_32x32x16_bf16 v[128:143], v[88:91], v[84:87], v[128:143]
    ds_read_b128 v[48:51], v25 offset:0
    ds_read_b128 v[52:55], v25 offset:4096
    ds_read_b64_tr_b16 v[56:57], v28 offset:2048
    v_mfma_f32_32x32x16_bf16 v[144:159], v[92:95], v[84:87], v[144:159]
    ds_read_b64_tr_b16 v[58:59], v28 offset:2560
    ds_read_b64_tr_b16 v[60:61], v29 offset:2048
    ds_read_b64_tr_b16 v[62:63], v29 offset:2560
    s_sub_u32 s36, s36, 1
    s_cmp_lg_u32 s36, 0
    s_cbranch_scc1 il_g4_kernel_loop_2
    s_waitcnt lgkmcnt(6)
    v_mfma_f32_32x32x16_bf16 v[96:111], v[40:43], v[32:35], v[96:111]
    ds_read_b128 v[64:67], v26 offset:0
    s_mov_b32 m0, s43
    s_nop 0
    buffer_load_dwordx4 v16, s[4:7], s34 offen offset:0 lds
    v_mfma_f32_32x32x16_bf16 v[112:127], v[44:47], v[32:35], v[112:127]
    ds_read_b128 v[68:71], v26 offset:4096
    ds_read_b64_tr_b16 v[72:73], v28 offset:4096
    v_mfma_f32_32x32x16_bf16 v[128:143], v[40:43], v[36:39], v[128:143]
    ds_read_b64_tr_b16 v[74:75], v28 offset:4608
    buffer_load_dwordx4 v17, s[4:7], s34 offen offset:1024 lds
    v_mfma_f32_32x32x16_bf16 v[144:159], v[44:47], v[36:39], v[144:159]
    ds_read_b64_tr_b16 v[76:77], v29 offset:4096
    ds_read_b64_tr_b16 v[78:79], v29 offset:4608
    s_waitcnt lgkmcnt(6)
    v_mfma_f32_32x32x16_bf16 v[96:111], v[56:59], v[48:51], v[96:111]
    ds_read_b128 v[80:83], v27 offset:0
    buffer_load_dwordx4 v18, s[4:7], s34 offen offset:2048 lds
    v_mfma_f32_32x32x16_bf16 v[112:127], v[60:63], v[48:51], v[112:127]
    ds_read_b128 v[84:87], v27 offset:4096
    ds_read_b64_tr_b16 v[88:89], v28 offset:6144
    v_mfma_f32_32x32x16_bf16 v[128:143], v[56:59], v[52:55], v[128:143]
    ds_read_b64_tr_b16 v[90:91], v28 offset:6656
    buffer_load_dwordx4 v19, s[4:7], s34 offen offset:3072 lds
    v_mfma_f32_32x32x16_bf16 v[144:159], v[60:63], v[52:55], v[144:159]
    ds_read_b64_tr_b16 v[92:93], v29 offset:6144
    ds_read_b64_tr_b16 v[94:95], v29 offset:6656
    s_waitcnt lgkmcnt(6)
    v_mfma_f32_32x32x16_bf16 v[96:111], v[72:75], v[64:67], v[96:111]
    s_mov_b32 m0, s51
    s_nop 0
    buffer_load_dwordx4 v20, s[8:11], s35 offen offset:0 lds
    v_mfma_f32_32x32x16_bf16 v[112:127], v[76:79], v[64:67], v[112:127]
    buffer_load_dwordx4 v21, s[8:11], s35 offen offset:1024 lds
    v_mfma_f32_32x32x16_bf16 v[128:143], v[72:75], v[68:71], v[128:143]
    buffer_load_dwordx4 v22, s[8:11], s35 offen offset:2048 lds
    v_mfma_f32_32x32x16_bf16 v[144:159], v[76:79], v[68:71], v[144:159]
    buffer_load_dwordx4 v23, s[8:11], s35 offen offset:3072 lds
    s_add_u32 s34, s34, 128
    s_add_u32 s35, s35, 0x20000
    s_waitcnt lgkmcnt(0)
    s_waitcnt vmcnt(16) lgkmcnt(0)
    s_barrier
    v_mfma_f32_32x32x16_bf16 v[96:111], v[88:91], v[80:83], v[96:111]
    ds_read_b128 v[32:35], v24 offset:16384
    ds_read_b128 v[36:39], v24 offset:20480
    ds_read_b64_tr_b16 v[40:41], v28 offset:16384
    v_mfma_f32_32x32x16_bf16 v[112:127], v[92:95], v[80:83], v[112:127]
    ds_read_b64_tr_b16 v[42:43], v28 offset:16896
    ds_read_b64_tr_b16 v[44:45], v29 offset:16384
    ds_read_b64_tr_b16 v[46:47], v29 offset:16896
    v_mfma_f32_32x32x16_bf16 v[128:143], v[88:91], v[84:87], v[128:143]
    ds_read_b128 v[48:51], v25 offset:16384
    ds_read_b128 v[52:55], v25 offset:20480
    ds_read_b64_tr_b16 v[56:57], v28 offset:18432
    v_mfma_f32_32x32x16_bf16 v[144:159], v[92:95], v[84:87], v[144:159]
    ds_read_b64_tr_b16 v[58:59], v28 offset:18944
    ds_read_b64_tr_b16 v[60:61], v29 offset:18432
    ds_read_b64_tr_b16 v[62:63], v29 offset:18944
    s_waitcnt lgkmcnt(6)
    v_mfma_f32_32x32x16_bf16 v[96:111], v[40:43], v[32:35], v[96:111]
    ds_read_b128 v[64:67], v26 offset:16384
    ds_read_b128 v[68:71], v26 offset:20480
    v_mfma_f32_32x32x16_bf16 v[112:127], v[44:47], v[32:35], v[112:127]
    ds_read_b64_tr_b16 v[72:73], v28 offset:20480
    v_mfma_f32_32x32x16_bf16 v[128:143], v[40:43], v[36:39], v[128:143]
    ds_read_b64_tr_b16 v[74:75], v28 offset:20992
    ds_read_b64_tr_b16 v[76:77], v29 offset:20480
    v_mfma_f32_32x32x16_bf16 v[144:159], v[44:47], v[36:39], v[144:159]
    ds_read_b64_tr_b16 v[78:79], v29 offset:20992
    s_waitcnt lgkmcnt(6)
    v_mfma_f32_32x32x16_bf16 v[96:111], v[56:59], v[48:51], v[96:111]
    ds_read_b128 v[80:83], v27 offset:16384
    ds_read_b128 v[84:87], v27 offset:20480
    v_mfma_f32_32x32x16_bf16 v[112:127], v[60:63], v[48:51], v[112:127]
    ds_read_b64_tr_b16 v[88:89], v28 offset:22528
    v_mfma_f32_32x32x16_bf16 v[128:143], v[56:59], v[52:55], v[128:143]
    ds_read_b64_tr_b16 v[90:91], v28 offset:23040
    ds_read_b64_tr_b16 v[92:93], v29 offset:22528
    v_mfma_f32_32x32x16_bf16 v[144:159], v[60:63], v[52:55], v[144:159]
    ds_read_b64_tr_b16 v[94:95], v29 offset:23040
    s_waitcnt lgkmcnt(6)
    v_mfma_f32_32x32x16_bf16 v[96:111], v[72:75], v[64:67], v[96:111]
    v_mfma_f32_32x32x16_bf16 v[112:127], v[76:79], v[64:67], v[112:127]
    v_mfma_f32_32x32x16_bf16 v[128:143], v[72:75], v[68:71], v[128:143]
    v_mfma_f32_32x32x16_bf16 v[144:159], v[76:79], v[68:71], v[144:159]
    s_waitcnt lgkmcnt(0)
    s_waitcnt vmcnt(8) lgkmcnt(0)
    s_barrier
    v_mfma_f32_32x32x16_bf16 v[96:111], v[88:91], v[80:83], v[96:111]
    ds_read_b128 v[32:35], v24 offset:32768
    ds_read_b128 v[36:39], v24 offset:36864
    ds_read_b64_tr_b16 v[40:41], v28 offset:32768
    v_mfma_f32_32x32x16_bf16 v[112:127], v[92:95], v[80:83], v[112:127]
    ds_read_b64_tr_b16 v[42:43], v28 offset:33280
    ds_read_b64_tr_b16 v[44:45], v29 offset:32768
    ds_read_b64_tr_b16 v[46:47], v29 offset:33280
    v_mfma_f32_32x32x16_bf16 v[128:143], v[88:91], v[84:87], v[128:143]
    ds_read_b128 v[48:51], v25 offset:32768
    ds_read_b128 v[52:55], v25 offset:36864
    ds_read_b64_tr_b16 v[56:57], v28 offset:34816
    v_mfma_f32_32x32x16_bf16 v[144:159], v[92:95], v[84:87], v[144:159]
    ds_read_b64_tr_b16 v[58:59], v28 offset:35328
    ds_read_b64_tr_b16 v[60:61], v29 offset:34816
    ds_read_b64_tr_b16 v[62:63], v29 offset:35328
    s_waitcnt lgkmcnt(6)
    v_mfma_f32_32x32x16_bf16 v[96:111], v[40:43], v[32:35], v[96:111]
    ds_read_b128 v[64:67], v26 offset:32768
    ds_read_b128 v[68:71], v26 offset:36864
    v_mfma_f32_32x32x16_bf16 v[112:127], v[44:47], v[32:35], v[112:127]
    ds_read_b64_tr_b16 v[72:73], v28 offset:36864
    v_mfma_f32_32x32x16_bf16 v[128:143], v[40:43], v[36:39], v[128:143]
    ds_read_b64_tr_b16 v[74:75], v28 offset:37376
    ds_read_b64_tr_b16 v[76:77], v29 offset:36864
    v_mfma_f32_32x32x16_bf16 v[144:159], v[44:47], v[36:39], v[144:159]
    ds_read_b64_tr_b16 v[78:79], v29 offset:37376
    s_waitcnt lgkmcnt(6)
    v_mfma_f32_32x32x16_bf16 v[96:111], v[56:59], v[48:51], v[96:111]
    ds_read_b128 v[80:83], v27 offset:32768
    ds_read_b128 v[84:87], v27 offset:36864
    v_mfma_f32_32x32x16_bf16 v[112:127], v[60:63], v[48:51], v[112:127]
    ds_read_b64_tr_b16 v[88:89], v28 offset:38912
    v_mfma_f32_32x32x16_bf16 v[128:143], v[56:59], v[52:55], v[128:143]
    ds_read_b64_tr_b16 v[90:91], v28 offset:39424
    ds_read_b64_tr_b16 v[92:93], v29 offset:38912
    v_mfma_f32_32x32x16_bf16 v[144:159], v[60:63], v[52:55], v[144:159]
    ds_read_b64_tr_b16 v[94:95], v29 offset:39424
    s_waitcnt lgkmcnt(6)
    v_mfma_f32_32x32x16_bf16 v[96:111], v[72:75], v[64:67], v[96:111]
    v_mfma_f32_32x32x16_bf16 v[112:127], v[76:79], v[64:67], v[112:127]
    v_mfma_f32_32x32x16_bf16 v[128:143], v[72:75], v[68:71], v[128:143]
    v_mfma_f32_32x32x16_bf16 v[144:159], v[76:79], v[68:71], v[144:159]
    s_waitcnt lgkmcnt(0)
    s_waitcnt vmcnt(0) lgkmcnt(0)
    s_barrier
    v_mfma_f32_32x32x16_bf16 v[96:111], v[88:91], v[80:83], v[96:111]
    ds_read_b128 v[32:35], v24 offset:49152
    ds_read_b128 v[36:39], v24 offset:53248
    ds_read_b64_tr_b16 v[40:41], v28 offset:49152
    v_mfma_f32_32x32x16_bf16 v[112:127], v[92:95], v[80:83], v[112:127]
    ds_read_b64_tr_b16 v[42:43], v28 offset:49664
    ds_read_b64_tr_b16 v[44:45], v29 offset:49152
    ds_read_b64_tr_b16 v[46:47], v29 offset:49664
    v_mfma_f32_32x32x16_bf16 v[128:143], v[88:91], v[84:87], v[128:143]
    ds_read_b128 v[48:51], v25 offset:49152
    ds_read_b128 v[52:55], v25 offset:53248
    ds_read_b64_tr_b16 v[56:57], v28 offset:51200
    v_mfma_f32_32x32x16_bf16 v[144:159], v[92:95], v[84:87], v[144:159]
    ds_read_b64_tr_b16 v[58:59], v28 offset:51712
    ds_read_b64_tr_b16 v[60:61], v29 offset:51200
    ds_read_b64_tr_b16 v[62:63], v29 offset:51712
    s_waitcnt lgkmcnt(6)
    v_mfma_f32_32x32x16_bf16 v[96:111], v[40:43], v[32:35], v[96:111]
    ds_read_b128 v[64:67], v26 offset:49152
    ds_read_b128 v[68:71], v26 offset:53248
    v_mfma_f32_32x32x16_bf16 v[112:127], v[44:47], v[32:35], v[112:127]
    ds_read_b64_tr_b16 v[72:73], v28 offset:53248
    v_mfma_f32_32x32x16_bf16 v[128:143], v[40:43], v[36:39], v[128:143]
    ds_read_b64_tr_b16 v[74:75], v28 offset:53760
    ds_read_b64_tr_b16 v[76:77], v29 offset:53248
    v_mfma_f32_32x32x16_bf16 v[144:159], v[44:47], v[36:39], v[144:159]
    ds_read_b64_tr_b16 v[78:79], v29 offset:53760
    s_waitcnt lgkmcnt(6)
    v_mfma_f32_32x32x16_bf16 v[96:111], v[56:59], v[48:51], v[96:111]
    ds_read_b128 v[80:83], v27 offset:49152
    ds_read_b128 v[84:87], v27 offset:53248
    v_mfma_f32_32x32x16_bf16 v[112:127], v[60:63], v[48:51], v[112:127]
    ds_read_b64_tr_b16 v[88:89], v28 offset:55296
    v_mfma_f32_32x32x16_bf16 v[128:143], v[56:59], v[52:55], v[128:143]
    ds_read_b64_tr_b16 v[90:91], v28 offset:55808
    ds_read_b64_tr_b16 v[92:93], v29 offset:55296
    v_mfma_f32_32x32x16_bf16 v[144:159], v[60:63], v[52:55], v[144:159]
    ds_read_b64_tr_b16 v[94:95], v29 offset:55808
    s_waitcnt lgkmcnt(6)
    v_mfma_f32_32x32x16_bf16 v[96:111], v[72:75], v[64:67], v[96:111]
    v_mfma_f32_32x32x16_bf16 v[112:127], v[76:79], v[64:67], v[112:127]
    v_mfma_f32_32x32x16_bf16 v[128:143], v[72:75], v[68:71], v[128:143]
    v_mfma_f32_32x32x16_bf16 v[144:159], v[76:79], v[68:71], v[144:159]
    s_waitcnt lgkmcnt(0)
    v_mfma_f32_32x32x16_bf16 v[96:111], v[88:91], v[80:83], v[96:111]
    v_mfma_f32_32x32x16_bf16 v[112:127], v[92:95], v[80:83], v[112:127]
    v_mfma_f32_32x32x16_bf16 v[128:143], v[88:91], v[84:87], v[128:143]
    v_mfma_f32_32x32x16_bf16 v[144:159], v[92:95], v[84:87], v[144:159]
    s_nop 15
    s_nop 3
    s_barrier
    s_mul_i32 s23, s20, 16384
    v_and_b32 v10, 15, v8
    v_xor_b32 v10, v10, v9
    v_lshlrev_b32 v10, 4, v10
    v_mul_u32_u24 v13, 256, v8
    v_add_u32 v10, v10, v13
    v_add_u32 v10, s23, v10
    v_lshrrev_b32 v13, 4, v2
    v_and_b32 v14, 15, v2
    v_and_b32 v15, 15, v13
    v_xor_b32 v15, v15, v14
    v_lshlrev_b32 v15, 4, v15
    v_mul_u32_u24 v11, 256, v13
    v_add_u32 v11, v11, v15
    v_add_u32 v11, s23, v11
    s_mul_i32 s23, s21, 64
    v_add_u32 v13, s23, v13
    v_mul_u32_u24 v12, 0x1000, v13
    v_lshl_add_u32 v12, v14, 4, v12
    s_mul_i32 s23, s22, 256
    v_add_u32 v12, s23, v12
    ds_write_b128 v10, v[96:99] offset:0
    v_xor_b32 v13, 0x20, v10
    ds_write_b128 v13, v[100:103] offset:0
    v_xor_b32 v13, 0x40, v10
    ds_write_b128 v13, v[104:107] offset:0
    v_xor_b32 v13, 0x60, v10
    ds_write_b128 v13, v[108:111] offset:0
    v_xor_b32 v13, 0x80, v10
    ds_write_b128 v13, v[112:115] offset:0
    v_xor_b32 v13, 0xa0, v10
    ds_write_b128 v13, v[116:119] offset:0
    v_xor_b32 v13, 0xc0, v10
    ds_write_b128 v13, v[120:123] offset:0
    v_xor_b32 v13, 0xe0, v10
    ds_write_b128 v13, v[124:127] offset:0
    ds_write_b128 v10, v[128:131] offset:8192
    v_xor_b32 v13, 0x20, v10
    ds_write_b128 v13, v[132:135] offset:8192
    v_xor_b32 v13, 0x40, v10
    ds_write_b128 v13, v[136:139] offset:8192
    v_xor_b32 v13, 0x60, v10
    ds_write_b128 v13, v[140:143] offset:8192
    v_xor_b32 v13, 0x80, v10
    ds_write_b128 v13, v[144:147] offset:8192
    v_xor_b32 v13, 0xa0, v10
    ds_write_b128 v13, v[148:151] offset:8192
    v_xor_b32 v13, 0xc0, v10
    ds_write_b128 v13, v[152:155] offset:8192
    v_xor_b32 v13, 0xe0, v10
    ds_write_b128 v13, v[156:159] offset:8192
    s_waitcnt lgkmcnt(0)
    ds_read_b128 v[96:99], v11 offset:0
    v_xor_b32 v13, 0x40, v11
    ds_read_b128 v[100:103], v13 offset:1024
    v_xor_b32 v13, 0x80, v11
    ds_read_b128 v[104:107], v13 offset:2048
    v_xor_b32 v13, 0xc0, v11
    ds_read_b128 v[108:111], v13 offset:3072
    ds_read_b128 v[112:115], v11 offset:4096
    v_xor_b32 v13, 0x40, v11
    ds_read_b128 v[116:119], v13 offset:5120
    v_xor_b32 v13, 0x80, v11
    ds_read_b128 v[120:123], v13 offset:6144
    v_xor_b32 v13, 0xc0, v11
    ds_read_b128 v[124:127], v13 offset:7168
    ds_read_b128 v[128:131], v11 offset:8192
    v_xor_b32 v13, 0x40, v11
    ds_read_b128 v[132:135], v13 offset:9216
    v_xor_b32 v13, 0x80, v11
    ds_read_b128 v[136:139], v13 offset:10240
    v_xor_b32 v13, 0xc0, v11
    ds_read_b128 v[140:143], v13 offset:11264
    ds_read_b128 v[144:147], v11 offset:12288
    v_xor_b32 v13, 0x40, v11
    ds_read_b128 v[148:151], v13 offset:13312
    v_xor_b32 v13, 0x80, v11
    ds_read_b128 v[152:155], v13 offset:14336
    v_xor_b32 v13, 0xc0, v11
    ds_read_b128 v[156:159], v13 offset:15360
    s_waitcnt lgkmcnt(15)
    buffer_store_dwordx4 v[96:99], v12, s[12:15], 0 offen sc1
    v_add_u32 v12, 0x4000, v12
    s_waitcnt lgkmcnt(14)
    buffer_store_dwordx4 v[100:103], v12, s[12:15], 0 offen sc1
    v_add_u32 v12, 0x4000, v12
    s_waitcnt lgkmcnt(13)
    buffer_store_dwordx4 v[104:107], v12, s[12:15], 0 offen sc1
    v_add_u32 v12, 0x4000, v12
    s_waitcnt lgkmcnt(12)
    buffer_store_dwordx4 v[108:111], v12, s[12:15], 0 offen sc1
    v_add_u32 v12, 0x4000, v12
    s_waitcnt lgkmcnt(11)
    buffer_store_dwordx4 v[112:115], v12, s[12:15], 0 offen sc1
    v_add_u32 v12, 0x4000, v12
    s_waitcnt lgkmcnt(10)
    buffer_store_dwordx4 v[116:119], v12, s[12:15], 0 offen sc1
    v_add_u32 v12, 0x4000, v12
    s_waitcnt lgkmcnt(9)
    buffer_store_dwordx4 v[120:123], v12, s[12:15], 0 offen sc1
    v_add_u32 v12, 0x4000, v12
    s_waitcnt lgkmcnt(8)
    buffer_store_dwordx4 v[124:127], v12, s[12:15], 0 offen sc1
    v_add_u32 v12, 0x4000, v12
    s_waitcnt lgkmcnt(7)
    buffer_store_dwordx4 v[128:131], v12, s[12:15], 0 offen sc1
    v_add_u32 v12, 0x4000, v12
    s_waitcnt lgkmcnt(6)
    buffer_store_dwordx4 v[132:135], v12, s[12:15], 0 offen sc1
    v_add_u32 v12, 0x4000, v12
    s_waitcnt lgkmcnt(5)
    buffer_store_dwordx4 v[136:139], v12, s[12:15], 0 offen sc1
    v_add_u32 v12, 0x4000, v12
    s_waitcnt lgkmcnt(4)
    buffer_store_dwordx4 v[140:143], v12, s[12:15], 0 offen sc1
    v_add_u32 v12, 0x4000, v12
    s_waitcnt lgkmcnt(3)
    buffer_store_dwordx4 v[144:147], v12, s[12:15], 0 offen sc1
    v_add_u32 v12, 0x4000, v12
    s_waitcnt lgkmcnt(2)
    buffer_store_dwordx4 v[148:151], v12, s[12:15], 0 offen sc1
    v_add_u32 v12, 0x4000, v12
    s_waitcnt lgkmcnt(1)
    buffer_store_dwordx4 v[152:155], v12, s[12:15], 0 offen sc1
    v_add_u32 v12, 0x4000, v12
    s_waitcnt lgkmcnt(0)
    buffer_store_dwordx4 v[156:159], v12, s[12:15], 0 offen sc1
il_g4_kernel_end_1:
    s_endpgm
.section .rodata,"a"
.p2align 6
.p2align 6
.amdhsa_kernel il_ln_first_kernel
  .amdhsa_next_free_vgpr 96
  .amdhsa_next_free_sgpr 102
  .amdhsa_accum_offset 96
  .amdhsa_group_segment_fixed_size 0
  .amdhsa_kernarg_size 96
  .amdhsa_user_sgpr_count 2
  .amdhsa_user_sgpr_kernarg_segment_ptr 1
  .amdhsa_system_sgpr_workgroup_id_x 1
.end_amdhsa_kernel
.p2align 6
.amdhsa_kernel il_ln_pq_kernel
  .amdhsa_next_free_vgpr 96
  .amdhsa_next_free_sgpr 102
  .amdhsa_accum_offset 96
  .amdhsa_group_segment_fixed_size 0
  .amdhsa_kernarg_size 96
  .amdhsa_user_sgpr_count 2
  .amdhsa_user_sgpr_kernarg_segment_ptr 1
  .amdhsa_system_sgpr_workgroup_id_x 1
.end_amdhsa_kernel
.p2align 6
.amdhsa_kernel il_ln_o_kernel
  .amdhsa_next_free_vgpr 96
  .amdhsa_next_free_sgpr 102
  .amdhsa_accum_offset 96
  .amdhsa_group_segment_fixed_size 0
  .amdhsa_kernarg_size 96
  .amdhsa_user_sgpr_count 2
  .amdhsa_user_sgpr_kernarg_segment_ptr 1
  .amdhsa_system_sgpr_workgroup_id_x 1
.end_amdhsa_kernel
.p2align 6
.amdhsa_kernel il_ln_final_kernel
  .amdhsa_next_free_vgpr 96
  .amdhsa_next_free_sgpr 102
  .amdhsa_accum_offset 96
  .amdhsa_group_segment_fixed_size 0
  .amdhsa_kernarg_size 96
  .amdhsa_user_sgpr_count 2
  .amdhsa_user_sgpr_kernarg_segment_ptr 1
  .amdhsa_system_sgpr_workgroup_id_x 1
.end_amdhsa_kernel
.p2align 6
.amdhsa_kernel il_g1_kernel
  .amdhsa_next_free_vgpr 160
  .amdhsa_next_free_sgpr 102
  .amdhsa_accum_offset 160
  .amdhsa_group_segment_fixed_size 0
  .amdhsa_kernarg_size 96
  .amdhsa_user_sgpr_count 2
  .amdhsa_user_sgpr_kernarg_segment_ptr 1
  .amdhsa_system_sgpr_workgroup_id_x 1
.end_amdhsa_kernel
.p2align 6
.amdhsa_kernel il_g2_kernel
  .amdhsa_next_free_vgpr 160
  .amdhsa_next_free_sgpr 102
  .amdhsa_accum_offset 160
  .amdhsa_group_segment_fixed_size 0
  .amdhsa_kernarg_size 96
  .amdhsa_user_sgpr_count 2
  .amdhsa_user_sgpr_kernarg_segment_ptr 1
  .amdhsa_system_sgpr_workgroup_id_x 1
.end_amdhsa_kernel
.p2align 6
.amdhsa_kernel il_g3_kernel
  .amdhsa_next_free_vgpr 256
  .amdhsa_next_free_sgpr 102
  .amdhsa_accum_offset 256
  .amdhsa_group_segment_fixed_size 0
  .amdhsa_kernarg_size 96
  .amdhsa_user_sgpr_count 2
  .amdhsa_user_sgpr_kernarg_segment_ptr 1
  .amdhsa_system_sgpr_workgroup_id_x 1
.end_amdhsa_kernel
.p2align 6
.amdhsa_kernel il_g4_kernel
  .amdhsa_next_free_vgpr 160
  .amdhsa_next_free_sgpr 102
  .amdhsa_accum_offset 160
  .amdhsa_group_segment_fixed_size 0
  .amdhsa_kernarg_size 96
  .amdhsa_user_sgpr_count 2
  .amdhsa_user_sgpr_kernarg_segment_ptr 1
  .amdhsa_system_sgpr_workgroup_id_x 1
.end_amdhsa_kernel
```
